```python
import torch

def _softmax(x, axis=-1):
    return torch.softmax(x, dim=axis)

def _gelu(x):
    return torch.nn.functional.gelu(x, approximate='tanh')

def _silu(x):
    return torch.nn.functional.silu(x)

def _sigmoid(x):
    return torch.sigmoid(x)

def _layernorm(x, axis=-1, eps=1e-05):
    m = x.mean(dim=axis, keepdim=True)
    v = x.var(dim=axis, keepdim=True, unbiased=False)
    return (x - m) / torch.sqrt(v + eps)

def _scatter_add(tgt, idx, src, axis=0):
    return tgt.clone().index_add_(axis, idx, src)

def _segment_sum(src, seg, n):
    out = torch.zeros((n,) + src.shape[1:], dtype=src.dtype)
    return out.index_add_(0, seg, src)

def _pad(x, pw):
    flat = tuple((v for pair in reversed(pw) for v in pair))
    return torch.nn.functional.pad(x, flat)
kernel_name = 'standalone__conformer_conv_module__speech'

def setup_inputs():

    _w = lambda a: (lambda t: t.to(torch.bfloat16) if t.is_floating_point() else t)(torch.as_tensor(a))
    B, T, D, K = (2, 4000, 512, 15)
    return {'x': _w((lambda *s: torch.randn(*s, dtype=torch.bfloat16) * 0.2)(B, T, D)), 'w_pw1': _w((lambda *s: torch.randn(*s, dtype=torch.bfloat16) * 0.2)(D, 2 * D)), 'dw': _w((lambda *s: torch.randn(*s, dtype=torch.bfloat16) * 0.2)(K, D)), 'w_pw2': _w((lambda *s: torch.randn(*s, dtype=torch.bfloat16) * 0.05)(D, D))}

def reference(x, w_pw1, dw, w_pw2):
    B, T, D = x.shape
    K = dw.shape[0]
    h = x @ w_pw1
    a, b = (h[..., :D].clone(), h[..., D:].clone())
    h = a * _sigmoid(b)
    pad = K // 2
    hp = _pad(h, ((0, 0), (pad, pad), (0, 0)))
    out = torch.zeros_like(h)
    for i in range(K):
        out = out + hp[:, i:i + T, :] * dw[i][None, None, :]
    return _silu(out) @ w_pw2
```

```asm
; @launch grid=(256,1,1) block=(512,1,1) lds=163840
.amdgcn_target "amdgcn-amd-amdhsa--gfx950"
.text
.globl standalone__conformer_conv_module__speech_kernel
.p2align 8
.type standalone__conformer_conv_module__speech_kernel,@function
standalone__conformer_conv_module__speech_kernel:
    s_cmp_ge_u32 s2, 256
    s_cbranch_scc1 L_end
    s_load_dwordx8 s[4:11], s[0:1], 0
    s_load_dwordx4 s[12:15], s[0:1], 32
    s_load_dwordx2 s[16:17], s[0:1], 48
    s_getpc_b64 s[18:19]
L_pc:
    v_lshlrev_b32 v5, 6, v0
    v_and_b32 v6, 1, v0
    v_lshl_or_b32 v6, v6, 20, v5
    v_cmp_gt_u32 vcc, L_code_end-L_pc, v6
    s_and_saveexec_b64 s[90:91], vcc
    s_cbranch_execz L_noct
    global_load_dword v2, v5, s[18:19]
L_noct:
    s_mov_b64 exec, -1
    v_lshrrev_b32 v7, 6, v0
    v_and_b32 v1, 63, v0
    v_readfirstlane_b32 s44, v7
    s_and_b32 s47, s2, 7
    s_lshr_b32 s53, s2, 3
    s_lshr_b32 s51, s53, 3
    s_lshl_b32 s45, s47, 2
    s_add_u32 s45, s45, s51
    s_and_b32 s46, s53, 7
    s_add_u32 s92, s46, s51
    s_and_b32 s92, s92, 2
    s_and_b32 s50, s45, 15
    s_mul_i32 s50, s50, 250
    s_sub_i32 s50, s50, 7
    s_lshl_b32 s56, s44, 10
    s_lshl_b32 s57, s44, 12
    s_add_u32 s57, s57, 16384
    v_lshrrev_b32 v5, 3, v1
    v_and_b32 v6, 7, v1
    v_lshrrev_b32 v21, 1, v5
    v_and_b32 v22, 1, v21
    v_lshlrev_b32 v22, 2, v22
    s_and_b32 s52, s44, 1
    s_lshl_b32 s52, s52, 1
    v_or_b32 v22, s52, v22
    v_xor_b32 v22, v22, v6
    v_lshlrev_b32 v22, 4, v22
    v_lshl_add_u32 v15, v5, 11, v22
    v_lshl_add_u32 v27, v5, 10, v22
    s_lshl_b32 s52, s44, 14
    s_lshl_b32 s53, s46, 7
    s_add_u32 s52, s52, s53
    v_add_u32 v15, s52, v15
    v_lshrrev_b32 v7, 2, v5
    v_and_b32 v8, 3, v5
    v_lshl_add_u32 v7, v7, 3, v8
    s_lshl_b32 s52, s44, 5
    s_add_i32 s52, s52, s50
    v_add_u32 v7, s52, v7
    v_xor_b32 v8, v21, v6
    v_lshlrev_b32 v8, 4, v8
    v_xor_b32 v9, 64, v8
    v_mov_b32 v20, 0x80000000
    v_lshl_add_u32 v10, v7, 10, v8
    v_lshl_add_u32 v11, v7, 10, v9
    v_add_u32 v12, 0x1000, v10
    v_add_u32 v13, 0x5000, v11
    v_add_u32 v11, 0x4000, v11
    v_cmp_gt_i32 vcc, 0, v7
    v_cmp_gt_i32 s[90:91], -4, v7
    s_add_i32 s52, s50, 256
    v_add_u32 v21, s52, v5
    v_cndmask_b32 v10, v10, v20, vcc
    v_cndmask_b32 v12, v12, v20, s[90:91]
    v_lshl_add_u32 v14, v21, 10, v8
    s_lshr_b32 s52, s45, 4
    s_mul_i32 s52, s52, 4096000
    s_mov_b32 s22, 4096000
    s_mov_b32 s23, 0x20000
    s_mov_b32 s26, 1048576
    s_mov_b32 s27, 0x20000
    s_waitcnt lgkmcnt(0)
    s_add_u32 s20, s4, s52
    s_addc_u32 s21, s5, 0
    s_mov_b32 s24, s6
    s_mov_b32 s25, s7
    s_xor_b32 s52, s92, 0
    s_add_u32 s52, s47, s52
    s_and_b32 s52, s52, 7
    s_lshl_b32 s53, s52, 17
    s_lshl_b32 s52, s52, 7
    s_add_u32 s54, s53, 1024
    s_cmp_eq_u32 s44, 7
    s_cbranch_scc0 L_noS_0
    s_mov_b32 m0, 49152
    s_nop 0
    buffer_load_dwordx4 v14, s[20:23], s52 offen lds
L_noS_0:
    s_add_u32 m0, s56, 0
    s_nop 0
    buffer_load_dwordx4 v15, s[24:27], s53 offen lds
    s_add_u32 m0, s56, 8192
    s_nop 0
    buffer_load_dwordx4 v15, s[24:27], s54 offen lds
    s_add_u32 m0, s57, 0
    s_nop 0
    buffer_load_dwordx4 v10, s[20:23], s52 offen lds
    s_add_u32 m0, s57, 1024
    s_nop 0
    buffer_load_dwordx4 v11, s[20:23], s52 offen lds
    s_add_u32 m0, s57, 2048
    s_nop 0
    buffer_load_dwordx4 v12, s[20:23], s52 offen lds
    s_add_u32 m0, s57, 3072
    s_nop 0
    buffer_load_dwordx4 v13, s[20:23], s52 offen lds
    s_mov_b32 s28, s8
    s_mov_b32 s29, s9
    s_mov_b32 s30, 15360
    s_mov_b32 s31, 0x20000
    v_lshrrev_b32 v21, 3, v0
    v_subrev_u32 v22, 7, v21
    v_lshlrev_b32 v23, 10, v22
    v_lshl_add_u32 v23, v6, 4, v23
    s_lshl_b32 s55, s46, 7
    v_add_u32 v23, s55, v23
    v_cmp_gt_i32 vcc, 0, v22
    v_mul_u32_u24 v16, 144, v21
    v_lshl_add_u32 v16, v6, 4, v16
    v_cndmask_b32 v23, v23, v20, vcc
    v_add_u32 v16, 150528, v16
    s_barrier
    s_cmp_lt_u32 s44, 4
    s_cbranch_scc0 L_nodw
    buffer_load_dwordx4 v[224:227], v23, s[28:31], 0 offen
L_nodw:
    s_xor_b32 s52, s92, 1
    s_add_u32 s52, s47, s52
    s_and_b32 s52, s52, 7
    s_lshl_b32 s53, s52, 17
    s_lshl_b32 s52, s52, 7
    s_add_u32 s54, s53, 1024
    s_cmp_eq_u32 s44, 7
    s_cbranch_scc0 L_noS_1
    s_mov_b32 m0, 99328
    s_nop 0
    buffer_load_dwordx4 v14, s[20:23], s52 offen lds
L_noS_1:
    s_add_u32 m0, s56, 50176
    s_nop 0
    buffer_load_dwordx4 v15, s[24:27], s53 offen lds
    s_add_u32 m0, s56, 58368
    s_nop 0
    buffer_load_dwordx4 v15, s[24:27], s54 offen lds
    s_add_u32 m0, s57, 50176
    s_nop 0
    buffer_load_dwordx4 v10, s[20:23], s52 offen lds
    s_add_u32 m0, s57, 51200
    s_nop 0
    buffer_load_dwordx4 v11, s[20:23], s52 offen lds
    s_add_u32 m0, s57, 52224
    s_nop 0
    buffer_load_dwordx4 v12, s[20:23], s52 offen lds
    s_add_u32 m0, s57, 53248
    s_nop 0
    buffer_load_dwordx4 v13, s[20:23], s52 offen lds
    s_mov_b32 s36, s16
    s_mov_b32 s37, s17
    s_mov_b32 s38, 0x1000000
    s_mov_b32 s39, 0x20000
    s_mov_b32 s40, s10
    s_mov_b32 s41, s11
    s_mov_b32 s42, 524288
    s_mov_b32 s43, 0x20000
    s_mul_i32 s52, s45, 256000
    s_add_u32 s32, s12, s52
    s_addc_u32 s33, s13, 0
    s_mov_b32 s34, 256000
    s_mov_b32 s35, 0x20000
    s_and_b32 s48, s44, 3
    v_and_b32 v3, 15, v1
    v_lshrrev_b32 v4, 4, v1
    s_lshl_b32 s52, s45, 3
    v_mov_b32 v28, s52
    s_getreg_b32 s49, hwreg(HW_REG_XCC_ID, 0, 4)
    s_and_b32 s49, s49, 7
    s_lshl_b32 s49, s49, 2
    s_cmp_eq_u32 s44, 5
    s_cbranch_scc0 L_nohello
    s_lshl_b32 s52, 1, s49
    v_mov_b32 v21, s52
    s_mov_b64 exec, 1
    global_atomic_add v28, v21, s[14:15] offset:4 sc1
    s_cmp_eq_u32 s46, 0
    s_cbranch_scc0 L_noep
    s_memrealtime s[58:59]
    s_waitcnt lgkmcnt(0)
    s_lshr_b64 s[58:59], s[58:59], 6
    s_or_b32 s58, s58, 0x80000000
    v_mov_b32 v21, s58
    global_store_dword v28, v21, s[14:15] sc1
L_noep:
    s_mov_b64 exec, -1
L_nohello:
    s_lshl_b32 s52, s48, 13
    s_and_b32 s53, s46, 3
    s_lshl_b32 s53, s53, 8
    s_add_u32 s52, s52, s53
    v_add_u32 v27, s52, v27
    v_add_u32 v29, 0x8000, v27
    s_mov_b32 s60, 0x05040100
    s_mov_b32 s61, 0x07060302
    s_mov_b32 s64, 0xbfb8aa3b
    s_mov_b32 s65, 0xbfb8aa3b
    v_lshrrev_b32 v5, 3, v3
    v_and_b32 v6, 7, v3
    v_lshlrev_b32 v5, 10, v5
    v_lshl_add_u32 v5, v6, 7, v5
    v_lshrrev_b32 v6, 1, v3
    v_xor_b32 v6, v6, v4
    v_lshl_add_u32 v7, v6, 4, v5
    v_xor_b32 v8, 64, v7
    v_add_u32 v18, 16384, v7
    v_add_u32 v19, 16384, v8
    v_add_u32 v20, 66560, v7
    v_add_u32 v21, 66560, v8
    v_add_u32 v22, 116736, v7
    v_add_u32 v23, 116736, v8
    v_lshrrev_b32 v5, 2, v3
    v_and_b32 v6, 3, v3
    v_lshrrev_b32 v7, 1, v6
    s_lshl_b32 s52, s48, 1
    v_or_b32 v7, s52, v7
    v_lshrrev_b32 v8, 1, v5
    v_lshlrev_b32 v8, 2, v8
    v_and_b32 v9, 1, v4
    v_lshl_or_b32 v8, v9, 1, v8
    v_xor_b32 v7, v7, v8
    v_lshlrev_b32 v7, 4, v7
    v_lshl_add_u32 v7, v5, 7, v7
    v_lshl_add_u32 v7, v4, 10, v7
    v_and_b32 v6, 1, v6
    v_lshl_add_u32 v7, v6, 3, v7
    v_add_u32 v24, 0, v7
    v_add_u32 v25, 50176, v7
    v_add_u32 v26, 100352, v7
    v_lshlrev_b32 v5, 3, v4
    v_sub_u32 v5, v5, v3
    v_add_u32 v5, 7, v5
    v_cmp_lt_u32 vcc, 21, v5
    v_mov_b32 v6, 22
    s_lshl_b32 s52, s44, 4
    v_cndmask_b32 v5, v5, v6, vcc
    v_mul_u32_u24 v5, 144, v5
    s_add_u32 s52, s52, 150528
    v_add_u32 v9, s52, v5
    s_cmp_ge_u32 s44, 4
    s_cbranch_scc1 L_path1
    s_waitcnt vmcnt(6)
    ds_write_b128 v16, v[224:227]
    v_mov_b32 v5, 155136
    v_mov_b32 v6, 0
    v_mov_b32 v7, 0
    ds_write_b64 v5, v[6:7]
    s_waitcnt lgkmcnt(0)
    s_barrier
    ds_read_b64_tr_b16 v[176:177], v24 offset:0
    ds_read_b64_tr_b16 v[178:179], v24 offset:512
    ds_read_b64_tr_b16 v[180:181], v24 offset:8192
    ds_read_b64_tr_b16 v[182:183], v24 offset:8704
    ds_read_b128 v[104:107], v18 offset:0
    ds_read_b128 v[108:111], v18 offset:2048
    ds_read_b128 v[112:115], v18 offset:4096
    ds_read_b128 v[116:119], v18 offset:6144
    ds_read_b128 v[120:123], v18 offset:8192
    ds_read_b128 v[124:127], v18 offset:10240
    ds_read_b128 v[128:131], v18 offset:12288
    ds_read_b128 v[132:135], v18 offset:14336
    ds_read_b128 v[136:139], v18 offset:32768
    s_waitcnt lgkmcnt(8)
    v_mfma_f32_16x16x32_bf16 v[32:35], v[104:107], v[176:179], 0
    ds_read_b64_tr_b16 v[184:185], v24 offset:4096
    v_mfma_f32_16x16x32_bf16 v[36:39], v[104:107], v[180:183], 0
    ds_read_b64_tr_b16 v[186:187], v24 offset:4608
    s_waitcnt lgkmcnt(9)
    v_mfma_f32_16x16x32_bf16 v[40:43], v[108:111], v[176:179], 0
    ds_read_b64_tr_b16 v[188:189], v24 offset:12288
    v_mfma_f32_16x16x32_bf16 v[44:47], v[108:111], v[180:183], 0
    ds_read_b64_tr_b16 v[190:191], v24 offset:12800
    s_waitcnt lgkmcnt(10)
    v_mfma_f32_16x16x32_bf16 v[48:51], v[112:115], v[176:179], 0
    ds_read_b128 v[140:143], v19 offset:0
    v_mfma_f32_16x16x32_bf16 v[52:55], v[112:115], v[180:183], 0
    ds_read_b128 v[144:147], v19 offset:2048
    s_waitcnt lgkmcnt(11)
    v_mfma_f32_16x16x32_bf16 v[56:59], v[116:119], v[176:179], 0
    ds_read_b128 v[148:151], v19 offset:4096
    v_mfma_f32_16x16x32_bf16 v[60:63], v[116:119], v[180:183], 0
    ds_read_b128 v[152:155], v19 offset:6144
    s_waitcnt lgkmcnt(12)
    v_mfma_f32_16x16x32_bf16 v[64:67], v[120:123], v[176:179], 0
    ds_read_b128 v[156:159], v19 offset:8192
    v_mfma_f32_16x16x32_bf16 v[68:71], v[120:123], v[180:183], 0
    ds_read_b128 v[160:163], v19 offset:10240
    s_waitcnt lgkmcnt(13)
    v_mfma_f32_16x16x32_bf16 v[72:75], v[124:127], v[176:179], 0
    ds_read_b128 v[164:167], v19 offset:12288
    v_mfma_f32_16x16x32_bf16 v[76:79], v[124:127], v[180:183], 0
    ds_read_b128 v[168:171], v19 offset:14336
    s_waitcnt lgkmcnt(14)
    v_mfma_f32_16x16x32_bf16 v[80:83], v[128:131], v[176:179], 0
    ds_read_b128 v[172:175], v19 offset:32768
    v_mfma_f32_16x16x32_bf16 v[84:87], v[128:131], v[180:183], 0
    s_waitcnt lgkmcnt(14)
    v_mfma_f32_16x16x32_bf16 v[88:91], v[132:135], v[176:179], 0
    v_mfma_f32_16x16x32_bf16 v[92:95], v[132:135], v[180:183], 0
    s_waitcnt lgkmcnt(13)
    v_mfma_f32_16x16x32_bf16 v[96:99], v[136:139], v[176:179], 0
    v_mfma_f32_16x16x32_bf16 v[100:103], v[136:139], v[180:183], 0
    s_xor_b32 s52, s92, 2
    s_add_u32 s52, s47, s52
    s_and_b32 s52, s52, 7
    s_lshl_b32 s53, s52, 17
    s_lshl_b32 s52, s52, 7
    s_add_u32 s54, s53, 1024
    s_add_u32 m0, s56, 100352
    s_nop 0
    buffer_load_dwordx4 v15, s[24:27], s53 offen lds
    s_add_u32 m0, s56, 108544
    s_nop 0
    buffer_load_dwordx4 v15, s[24:27], s54 offen lds
    s_add_u32 m0, s57, 100352
    s_nop 0
    buffer_load_dwordx4 v10, s[20:23], s52 offen lds
    s_add_u32 m0, s57, 101376
    s_nop 0
    buffer_load_dwordx4 v11, s[20:23], s52 offen lds
    s_add_u32 m0, s57, 102400
    s_nop 0
    buffer_load_dwordx4 v12, s[20:23], s52 offen lds
    s_add_u32 m0, s57, 103424
    s_nop 0
    buffer_load_dwordx4 v13, s[20:23], s52 offen lds
    s_waitcnt vmcnt(6) lgkmcnt(0)
    s_barrier
    s_xor_b32 s52, s92, 3
    s_add_u32 s52, s47, s52
    s_and_b32 s52, s52, 7
    s_lshl_b32 s53, s52, 17
    s_lshl_b32 s52, s52, 7
    s_add_u32 s54, s53, 1024
    s_add_u32 m0, s56, 0
    s_nop 0
    buffer_load_dwordx4 v15, s[24:27], s53 offen lds
    s_add_u32 m0, s56, 8192
    s_nop 0
    buffer_load_dwordx4 v15, s[24:27], s54 offen lds
    s_add_u32 m0, s57, 0
    s_nop 0
    buffer_load_dwordx4 v10, s[20:23], s52 offen lds
    s_add_u32 m0, s57, 1024
    s_nop 0
    buffer_load_dwordx4 v11, s[20:23], s52 offen lds
    s_add_u32 m0, s57, 2048
    s_nop 0
    buffer_load_dwordx4 v12, s[20:23], s52 offen lds
    s_add_u32 m0, s57, 3072
    s_nop 0
    buffer_load_dwordx4 v13, s[20:23], s52 offen lds
    v_mfma_f32_16x16x32_bf16 v[32:35], v[140:143], v[184:187], v[32:35]
    ds_read_b64_tr_b16 v[176:177], v25 offset:0
    v_mfma_f32_16x16x32_bf16 v[36:39], v[140:143], v[188:191], v[36:39]
    ds_read_b64_tr_b16 v[178:179], v25 offset:512
    v_mfma_f32_16x16x32_bf16 v[40:43], v[144:147], v[184:187], v[40:43]
    ds_read_b64_tr_b16 v[180:181], v25 offset:8192
    v_mfma_f32_16x16x32_bf16 v[44:47], v[144:147], v[188:191], v[44:47]
    ds_read_b64_tr_b16 v[182:183], v25 offset:8704
    v_mfma_f32_16x16x32_bf16 v[48:51], v[148:151], v[184:187], v[48:51]
    ds_read_b128 v[104:107], v20 offset:0
    v_mfma_f32_16x16x32_bf16 v[52:55], v[148:151], v[188:191], v[52:55]
    ds_read_b128 v[108:111], v20 offset:2048
    v_mfma_f32_16x16x32_bf16 v[56:59], v[152:155], v[184:187], v[56:59]
    ds_read_b128 v[112:115], v20 offset:4096
    v_mfma_f32_16x16x32_bf16 v[60:63], v[152:155], v[188:191], v[60:63]
    ds_read_b128 v[116:119], v20 offset:6144
    v_mfma_f32_16x16x32_bf16 v[64:67], v[156:159], v[184:187], v[64:67]
    ds_read_b128 v[120:123], v20 offset:8192
    v_mfma_f32_16x16x32_bf16 v[68:71], v[156:159], v[188:191], v[68:71]
    ds_read_b128 v[124:127], v20 offset:10240
    v_mfma_f32_16x16x32_bf16 v[72:75], v[160:163], v[184:187], v[72:75]
    ds_read_b128 v[128:131], v20 offset:12288
    v_mfma_f32_16x16x32_bf16 v[76:79], v[160:163], v[188:191], v[76:79]
    ds_read_b128 v[132:135], v20 offset:14336
    v_mfma_f32_16x16x32_bf16 v[80:83], v[164:167], v[184:187], v[80:83]
    ds_read_b128 v[136:139], v20 offset:32768
    v_mfma_f32_16x16x32_bf16 v[84:87], v[164:167], v[188:191], v[84:87]
    v_mfma_f32_16x16x32_bf16 v[88:91], v[168:171], v[184:187], v[88:91]
    v_mfma_f32_16x16x32_bf16 v[92:95], v[168:171], v[188:191], v[92:95]
    v_mfma_f32_16x16x32_bf16 v[96:99], v[172:175], v[184:187], v[96:99]
    v_mfma_f32_16x16x32_bf16 v[100:103], v[172:175], v[188:191], v[100:103]
    s_waitcnt lgkmcnt(8)
    v_mfma_f32_16x16x32_bf16 v[32:35], v[104:107], v[176:179], v[32:35]
    ds_read_b128 v[224:227], v9 offset:0
    ds_read_b128 v[228:231], v9 offset:144
    v_mfma_f32_16x16x32_bf16 v[36:39], v[104:107], v[180:183], v[36:39]
    ds_read_b128 v[232:235], v9 offset:288
    ds_read_b128 v[236:239], v9 offset:432
    s_waitcnt lgkmcnt(11)
    v_mfma_f32_16x16x32_bf16 v[40:43], v[108:111], v[176:179], v[40:43]
    ds_read_b128 v[240:243], v9 offset:576
    ds_read_b128 v[244:247], v9 offset:720
    v_mfma_f32_16x16x32_bf16 v[44:47], v[108:111], v[180:183], v[44:47]
    ds_read_b128 v[248:251], v9 offset:864
    ds_read_b128 v[252:255], v9 offset:1008
    s_waitcnt lgkmcnt(14)
    v_mfma_f32_16x16x32_bf16 v[48:51], v[112:115], v[176:179], v[48:51]
    ds_read_b64_tr_b16 v[184:185], v25 offset:4096
    ds_read_b64_tr_b16 v[186:187], v25 offset:4608
    v_mfma_f32_16x16x32_bf16 v[52:55], v[112:115], v[180:183], v[52:55]
    ds_read_b64_tr_b16 v[188:189], v25 offset:12288
    s_waitcnt lgkmcnt(15)
    v_mfma_f32_16x16x32_bf16 v[56:59], v[116:119], v[176:179], v[56:59]
    ds_read_b64_tr_b16 v[190:191], v25 offset:12800
    v_mfma_f32_16x16x32_bf16 v[60:63], v[116:119], v[180:183], v[60:63]
    ds_read_b128 v[140:143], v21 offset:0
    s_waitcnt lgkmcnt(15)
    v_mfma_f32_16x16x32_bf16 v[64:67], v[120:123], v[176:179], v[64:67]
    ds_read_b128 v[144:147], v21 offset:2048
    v_mfma_f32_16x16x32_bf16 v[68:71], v[120:123], v[180:183], v[68:71]
    ds_read_b128 v[148:151], v21 offset:4096
    s_waitcnt lgkmcnt(15)
    v_mfma_f32_16x16x32_bf16 v[72:75], v[124:127], v[176:179], v[72:75]
    ds_read_b128 v[152:155], v21 offset:6144
    v_mfma_f32_16x16x32_bf16 v[76:79], v[124:127], v[180:183], v[76:79]
    ds_read_b128 v[156:159], v21 offset:8192
    s_waitcnt lgkmcnt(15)
    v_mfma_f32_16x16x32_bf16 v[80:83], v[128:131], v[176:179], v[80:83]
    ds_read_b128 v[160:163], v21 offset:10240
    v_mfma_f32_16x16x32_bf16 v[84:87], v[128:131], v[180:183], v[84:87]
    ds_read_b128 v[164:167], v21 offset:12288
    s_waitcnt lgkmcnt(15)
    v_mfma_f32_16x16x32_bf16 v[88:91], v[132:135], v[176:179], v[88:91]
    ds_read_b128 v[168:171], v21 offset:14336
    v_mfma_f32_16x16x32_bf16 v[92:95], v[132:135], v[180:183], v[92:95]
    ds_read_b128 v[172:175], v21 offset:32768
    s_waitcnt lgkmcnt(15)
    v_mfma_f32_16x16x32_bf16 v[96:99], v[136:139], v[176:179], v[96:99]
    v_mfma_f32_16x16x32_bf16 v[100:103], v[136:139], v[180:183], v[100:103]
    s_waitcnt vmcnt(6) lgkmcnt(0)
    s_barrier
    s_xor_b32 s52, s92, 4
    s_add_u32 s52, s47, s52
    s_and_b32 s52, s52, 7
    s_lshl_b32 s53, s52, 17
    s_lshl_b32 s52, s52, 7
    s_add_u32 s54, s53, 1024
    s_add_u32 m0, s56, 50176
    s_nop 0
    buffer_load_dwordx4 v15, s[24:27], s53 offen lds
    s_add_u32 m0, s56, 58368
    s_nop 0
    buffer_load_dwordx4 v15, s[24:27], s54 offen lds
    s_add_u32 m0, s57, 50176
    s_nop 0
    buffer_load_dwordx4 v10, s[20:23], s52 offen lds
    s_add_u32 m0, s57, 51200
    s_nop 0
    buffer_load_dwordx4 v11, s[20:23], s52 offen lds
    s_add_u32 m0, s57, 52224
    s_nop 0
    buffer_load_dwordx4 v12, s[20:23], s52 offen lds
    s_add_u32 m0, s57, 53248
    s_nop 0
    buffer_load_dwordx4 v13, s[20:23], s52 offen lds
    v_mfma_f32_16x16x32_bf16 v[32:35], v[140:143], v[184:187], v[32:35]
    ds_read_b64_tr_b16 v[176:177], v26 offset:0
    v_mfma_f32_16x16x32_bf16 v[36:39], v[140:143], v[188:191], v[36:39]
    ds_read_b64_tr_b16 v[178:179], v26 offset:512
    v_mfma_f32_16x16x32_bf16 v[40:43], v[144:147], v[184:187], v[40:43]
    ds_read_b64_tr_b16 v[180:181], v26 offset:8192
    v_mfma_f32_16x16x32_bf16 v[44:47], v[144:147], v[188:191], v[44:47]
    ds_read_b64_tr_b16 v[182:183], v26 offset:8704
    v_mfma_f32_16x16x32_bf16 v[48:51], v[148:151], v[184:187], v[48:51]
    ds_read_b128 v[104:107], v22 offset:0
    v_mfma_f32_16x16x32_bf16 v[52:55], v[148:151], v[188:191], v[52:55]
    ds_read_b128 v[108:111], v22 offset:2048
    v_mfma_f32_16x16x32_bf16 v[56:59], v[152:155], v[184:187], v[56:59]
    ds_read_b128 v[112:115], v22 offset:4096
    v_mfma_f32_16x16x32_bf16 v[60:63], v[152:155], v[188:191], v[60:63]
    ds_read_b128 v[116:119], v22 offset:6144
    v_mfma_f32_16x16x32_bf16 v[64:67], v[156:159], v[184:187], v[64:67]
    ds_read_b128 v[120:123], v22 offset:8192
    v_mfma_f32_16x16x32_bf16 v[68:71], v[156:159], v[188:191], v[68:71]
    ds_read_b128 v[124:127], v22 offset:10240
    v_mfma_f32_16x16x32_bf16 v[72:75], v[160:163], v[184:187], v[72:75]
    ds_read_b128 v[128:131], v22 offset:12288
    v_mfma_f32_16x16x32_bf16 v[76:79], v[160:163], v[188:191], v[76:79]
    ds_read_b128 v[132:135], v22 offset:14336
    v_mfma_f32_16x16x32_bf16 v[80:83], v[164:167], v[184:187], v[80:83]
    ds_read_b128 v[136:139], v22 offset:32768
    v_mfma_f32_16x16x32_bf16 v[84:87], v[164:167], v[188:191], v[84:87]
    v_perm_b32 v192, v228, v224, s60
    v_mfma_f32_16x16x32_bf16 v[88:91], v[168:171], v[184:187], v[88:91]
    v_perm_b32 v193, v236, v232, s60
    v_mfma_f32_16x16x32_bf16 v[92:95], v[168:171], v[188:191], v[92:95]
    v_perm_b32 v194, v244, v240, s60
    v_mfma_f32_16x16x32_bf16 v[96:99], v[172:175], v[184:187], v[96:99]
    v_perm_b32 v195, v252, v248, s60
    v_mfma_f32_16x16x32_bf16 v[100:103], v[172:175], v[188:191], v[100:103]
    v_perm_b32 v196, v228, v224, s61
    s_waitcnt lgkmcnt(8)
    v_mfma_f32_16x16x32_bf16 v[32:35], v[104:107], v[176:179], v[32:35]
    ds_read_b64_tr_b16 v[184:185], v26 offset:4096
    v_mfma_f32_16x16x32_bf16 v[36:39], v[104:107], v[180:183], v[36:39]
    ds_read_b64_tr_b16 v[186:187], v26 offset:4608
    s_waitcnt lgkmcnt(9)
    v_mfma_f32_16x16x32_bf16 v[40:43], v[108:111], v[176:179], v[40:43]
    ds_read_b64_tr_b16 v[188:189], v26 offset:12288
    v_mfma_f32_16x16x32_bf16 v[44:47], v[108:111], v[180:183], v[44:47]
    ds_read_b64_tr_b16 v[190:191], v26 offset:12800
    s_waitcnt lgkmcnt(10)
    v_mfma_f32_16x16x32_bf16 v[48:51], v[112:115], v[176:179], v[48:51]
    ds_read_b128 v[140:143], v23 offset:0
    v_mfma_f32_16x16x32_bf16 v[52:55], v[112:115], v[180:183], v[52:55]
    ds_read_b128 v[144:147], v23 offset:2048
    s_waitcnt lgkmcnt(11)
    v_mfma_f32_16x16x32_bf16 v[56:59], v[116:119], v[176:179], v[56:59]
    ds_read_b128 v[148:151], v23 offset:4096
    v_mfma_f32_16x16x32_bf16 v[60:63], v[116:119], v[180:183], v[60:63]
    ds_read_b128 v[152:155], v23 offset:6144
    s_waitcnt lgkmcnt(12)
    v_mfma_f32_16x16x32_bf16 v[64:67], v[120:123], v[176:179], v[64:67]
    ds_read_b128 v[156:159], v23 offset:8192
    v_mfma_f32_16x16x32_bf16 v[68:71], v[120:123], v[180:183], v[68:71]
    ds_read_b128 v[160:163], v23 offset:10240
    s_waitcnt lgkmcnt(13)
    v_mfma_f32_16x16x32_bf16 v[72:75], v[124:127], v[176:179], v[72:75]
    ds_read_b128 v[164:167], v23 offset:12288
    v_mfma_f32_16x16x32_bf16 v[76:79], v[124:127], v[180:183], v[76:79]
    ds_read_b128 v[168:171], v23 offset:14336
    s_waitcnt lgkmcnt(14)
    v_mfma_f32_16x16x32_bf16 v[80:83], v[128:131], v[176:179], v[80:83]
    ds_read_b128 v[172:175], v23 offset:32768
    v_mfma_f32_16x16x32_bf16 v[84:87], v[128:131], v[180:183], v[84:87]
    v_perm_b32 v197, v236, v232, s61
    s_waitcnt lgkmcnt(14)
    v_mfma_f32_16x16x32_bf16 v[88:91], v[132:135], v[176:179], v[88:91]
    v_perm_b32 v198, v244, v240, s61
    v_mfma_f32_16x16x32_bf16 v[92:95], v[132:135], v[180:183], v[92:95]
    v_perm_b32 v199, v252, v248, s61
    s_waitcnt lgkmcnt(13)
    v_mfma_f32_16x16x32_bf16 v[96:99], v[136:139], v[176:179], v[96:99]
    v_perm_b32 v200, v229, v225, s60
    v_mfma_f32_16x16x32_bf16 v[100:103], v[136:139], v[180:183], v[100:103]
    v_perm_b32 v201, v237, v233, s60
    s_waitcnt vmcnt(6) lgkmcnt(0)
    s_barrier
    s_xor_b32 s52, s92, 5
    s_add_u32 s52, s47, s52
    s_and_b32 s52, s52, 7
    s_lshl_b32 s53, s52, 17
    s_lshl_b32 s52, s52, 7
    s_add_u32 s54, s53, 1024
    s_add_u32 m0, s56, 100352
    s_nop 0
    buffer_load_dwordx4 v15, s[24:27], s53 offen lds
    s_add_u32 m0, s56, 108544
    s_nop 0
    buffer_load_dwordx4 v15, s[24:27], s54 offen lds
    s_add_u32 m0, s57, 100352
    s_nop 0
    buffer_load_dwordx4 v10, s[20:23], s52 offen lds
    s_add_u32 m0, s57, 101376
    s_nop 0
    buffer_load_dwordx4 v11, s[20:23], s52 offen lds
    s_add_u32 m0, s57, 102400
    s_nop 0
    buffer_load_dwordx4 v12, s[20:23], s52 offen lds
    s_add_u32 m0, s57, 103424
    s_nop 0
    buffer_load_dwordx4 v13, s[20:23], s52 offen lds
    v_mfma_f32_16x16x32_bf16 v[32:35], v[140:143], v[184:187], v[32:35]
    ds_read_b64_tr_b16 v[176:177], v24 offset:0
    v_mfma_f32_16x16x32_bf16 v[36:39], v[140:143], v[188:191], v[36:39]
    ds_read_b64_tr_b16 v[178:179], v24 offset:512
    v_mfma_f32_16x16x32_bf16 v[40:43], v[144:147], v[184:187], v[40:43]
    ds_read_b64_tr_b16 v[180:181], v24 offset:8192
    v_mfma_f32_16x16x32_bf16 v[44:47], v[144:147], v[188:191], v[44:47]
    ds_read_b64_tr_b16 v[182:183], v24 offset:8704
    v_mfma_f32_16x16x32_bf16 v[48:51], v[148:151], v[184:187], v[48:51]
    ds_read_b128 v[104:107], v18 offset:0
    v_mfma_f32_16x16x32_bf16 v[52:55], v[148:151], v[188:191], v[52:55]
    ds_read_b128 v[108:111], v18 offset:2048
    v_mfma_f32_16x16x32_bf16 v[56:59], v[152:155], v[184:187], v[56:59]
    ds_read_b128 v[112:115], v18 offset:4096
    v_mfma_f32_16x16x32_bf16 v[60:63], v[152:155], v[188:191], v[60:63]
    ds_read_b128 v[116:119], v18 offset:6144
    v_mfma_f32_16x16x32_bf16 v[64:67], v[156:159], v[184:187], v[64:67]
    ds_read_b128 v[120:123], v18 offset:8192
    v_mfma_f32_16x16x32_bf16 v[68:71], v[156:159], v[188:191], v[68:71]
    ds_read_b128 v[124:127], v18 offset:10240
    v_mfma_f32_16x16x32_bf16 v[72:75], v[160:163], v[184:187], v[72:75]
    ds_read_b128 v[128:131], v18 offset:12288
    v_mfma_f32_16x16x32_bf16 v[76:79], v[160:163], v[188:191], v[76:79]
    ds_read_b128 v[132:135], v18 offset:14336
    v_mfma_f32_16x16x32_bf16 v[80:83], v[164:167], v[184:187], v[80:83]
    ds_read_b128 v[136:139], v18 offset:32768
    v_mfma_f32_16x16x32_bf16 v[84:87], v[164:167], v[188:191], v[84:87]
    v_perm_b32 v202, v245, v241, s60
    v_mfma_f32_16x16x32_bf16 v[88:91], v[168:171], v[184:187], v[88:91]
    v_perm_b32 v203, v253, v249, s60
    v_mfma_f32_16x16x32_bf16 v[92:95], v[168:171], v[188:191], v[92:95]
    v_perm_b32 v204, v229, v225, s61
    v_mfma_f32_16x16x32_bf16 v[96:99], v[172:175], v[184:187], v[96:99]
    v_perm_b32 v205, v237, v233, s61
    v_mfma_f32_16x16x32_bf16 v[100:103], v[172:175], v[188:191], v[100:103]
    v_perm_b32 v206, v245, v241, s61
    s_waitcnt lgkmcnt(8)
    v_mfma_f32_16x16x32_bf16 v[32:35], v[104:107], v[176:179], v[32:35]
    ds_read_b64_tr_b16 v[184:185], v24 offset:4096
    v_mfma_f32_16x16x32_bf16 v[36:39], v[104:107], v[180:183], v[36:39]
    ds_read_b64_tr_b16 v[186:187], v24 offset:4608
    s_waitcnt lgkmcnt(9)
    v_mfma_f32_16x16x32_bf16 v[40:43], v[108:111], v[176:179], v[40:43]
    ds_read_b64_tr_b16 v[188:189], v24 offset:12288
    v_mfma_f32_16x16x32_bf16 v[44:47], v[108:111], v[180:183], v[44:47]
    ds_read_b64_tr_b16 v[190:191], v24 offset:12800
    s_waitcnt lgkmcnt(10)
    v_mfma_f32_16x16x32_bf16 v[48:51], v[112:115], v[176:179], v[48:51]
    ds_read_b128 v[140:143], v19 offset:0
    v_mfma_f32_16x16x32_bf16 v[52:55], v[112:115], v[180:183], v[52:55]
    ds_read_b128 v[144:147], v19 offset:2048
    s_waitcnt lgkmcnt(11)
    v_mfma_f32_16x16x32_bf16 v[56:59], v[116:119], v[176:179], v[56:59]
    ds_read_b128 v[148:151], v19 offset:4096
    v_mfma_f32_16x16x32_bf16 v[60:63], v[116:119], v[180:183], v[60:63]
    ds_read_b128 v[152:155], v19 offset:6144
    s_waitcnt lgkmcnt(12)
    v_mfma_f32_16x16x32_bf16 v[64:67], v[120:123], v[176:179], v[64:67]
    ds_read_b128 v[156:159], v19 offset:8192
    v_mfma_f32_16x16x32_bf16 v[68:71], v[120:123], v[180:183], v[68:71]
    ds_read_b128 v[160:163], v19 offset:10240
    s_waitcnt lgkmcnt(13)
    v_mfma_f32_16x16x32_bf16 v[72:75], v[124:127], v[176:179], v[72:75]
    ds_read_b128 v[164:167], v19 offset:12288
    v_mfma_f32_16x16x32_bf16 v[76:79], v[124:127], v[180:183], v[76:79]
    ds_read_b128 v[168:171], v19 offset:14336
    s_waitcnt lgkmcnt(14)
    v_mfma_f32_16x16x32_bf16 v[80:83], v[128:131], v[176:179], v[80:83]
    ds_read_b128 v[172:175], v19 offset:32768
    v_mfma_f32_16x16x32_bf16 v[84:87], v[128:131], v[180:183], v[84:87]
    v_perm_b32 v207, v253, v249, s61
    s_waitcnt lgkmcnt(14)
    v_mfma_f32_16x16x32_bf16 v[88:91], v[132:135], v[176:179], v[88:91]
    v_perm_b32 v208, v230, v226, s60
    v_mfma_f32_16x16x32_bf16 v[92:95], v[132:135], v[180:183], v[92:95]
    v_perm_b32 v209, v238, v234, s60
    s_waitcnt lgkmcnt(13)
    v_mfma_f32_16x16x32_bf16 v[96:99], v[136:139], v[176:179], v[96:99]
    v_perm_b32 v210, v246, v242, s60
    v_mfma_f32_16x16x32_bf16 v[100:103], v[136:139], v[180:183], v[100:103]
    v_perm_b32 v211, v254, v250, s60
    s_waitcnt vmcnt(6) lgkmcnt(0)
    s_barrier
    s_xor_b32 s52, s92, 6
    s_add_u32 s52, s47, s52
    s_and_b32 s52, s52, 7
    s_lshl_b32 s53, s52, 17
    s_lshl_b32 s52, s52, 7
    s_add_u32 s54, s53, 1024
    s_add_u32 m0, s56, 0
    s_nop 0
    buffer_load_dwordx4 v15, s[24:27], s53 offen lds
    s_add_u32 m0, s56, 8192
    s_nop 0
    buffer_load_dwordx4 v15, s[24:27], s54 offen lds
    s_add_u32 m0, s57, 0
    s_nop 0
    buffer_load_dwordx4 v10, s[20:23], s52 offen lds
    s_add_u32 m0, s57, 1024
    s_nop 0
    buffer_load_dwordx4 v11, s[20:23], s52 offen lds
    s_add_u32 m0, s57, 2048
    s_nop 0
    buffer_load_dwordx4 v12, s[20:23], s52 offen lds
    s_add_u32 m0, s57, 3072
    s_nop 0
    buffer_load_dwordx4 v13, s[20:23], s52 offen lds
    v_mfma_f32_16x16x32_bf16 v[32:35], v[140:143], v[184:187], v[32:35]
    ds_read_b64_tr_b16 v[176:177], v25 offset:0
    v_mfma_f32_16x16x32_bf16 v[36:39], v[140:143], v[188:191], v[36:39]
    ds_read_b64_tr_b16 v[178:179], v25 offset:512
    v_mfma_f32_16x16x32_bf16 v[40:43], v[144:147], v[184:187], v[40:43]
    ds_read_b64_tr_b16 v[180:181], v25 offset:8192
    v_mfma_f32_16x16x32_bf16 v[44:47], v[144:147], v[188:191], v[44:47]
    ds_read_b64_tr_b16 v[182:183], v25 offset:8704
    v_mfma_f32_16x16x32_bf16 v[48:51], v[148:151], v[184:187], v[48:51]
    ds_read_b128 v[104:107], v20 offset:0
    v_mfma_f32_16x16x32_bf16 v[52:55], v[148:151], v[188:191], v[52:55]
    ds_read_b128 v[108:111], v20 offset:2048
    v_mfma_f32_16x16x32_bf16 v[56:59], v[152:155], v[184:187], v[56:59]
    ds_read_b128 v[112:115], v20 offset:4096
    v_mfma_f32_16x16x32_bf16 v[60:63], v[152:155], v[188:191], v[60:63]
    ds_read_b128 v[116:119], v20 offset:6144
    v_mfma_f32_16x16x32_bf16 v[64:67], v[156:159], v[184:187], v[64:67]
    ds_read_b128 v[120:123], v20 offset:8192
    v_mfma_f32_16x16x32_bf16 v[68:71], v[156:159], v[188:191], v[68:71]
    ds_read_b128 v[124:127], v20 offset:10240
    v_mfma_f32_16x16x32_bf16 v[72:75], v[160:163], v[184:187], v[72:75]
    ds_read_b128 v[128:131], v20 offset:12288
    v_mfma_f32_16x16x32_bf16 v[76:79], v[160:163], v[188:191], v[76:79]
    ds_read_b128 v[132:135], v20 offset:14336
    v_mfma_f32_16x16x32_bf16 v[80:83], v[164:167], v[184:187], v[80:83]
    ds_read_b128 v[136:139], v20 offset:32768
    v_mfma_f32_16x16x32_bf16 v[84:87], v[164:167], v[188:191], v[84:87]
    v_perm_b32 v212, v230, v226, s61
    v_mfma_f32_16x16x32_bf16 v[88:91], v[168:171], v[184:187], v[88:91]
    v_perm_b32 v213, v238, v234, s61
    v_mfma_f32_16x16x32_bf16 v[92:95], v[168:171], v[188:191], v[92:95]
    v_perm_b32 v214, v246, v242, s61
    v_mfma_f32_16x16x32_bf16 v[96:99], v[172:175], v[184:187], v[96:99]
    v_perm_b32 v215, v254, v250, s61
    v_mfma_f32_16x16x32_bf16 v[100:103], v[172:175], v[188:191], v[100:103]
    v_perm_b32 v216, v231, v227, s60
    s_waitcnt lgkmcnt(8)
    v_mfma_f32_16x16x32_bf16 v[32:35], v[104:107], v[176:179], v[32:35]
    ds_read_b64_tr_b16 v[184:185], v25 offset:4096
    v_mfma_f32_16x16x32_bf16 v[36:39], v[104:107], v[180:183], v[36:39]
    ds_read_b64_tr_b16 v[186:187], v25 offset:4608
    s_waitcnt lgkmcnt(9)
    v_mfma_f32_16x16x32_bf16 v[40:43], v[108:111], v[176:179], v[40:43]
    ds_read_b64_tr_b16 v[188:189], v25 offset:12288
    v_mfma_f32_16x16x32_bf16 v[44:47], v[108:111], v[180:183], v[44:47]
    ds_read_b64_tr_b16 v[190:191], v25 offset:12800
    s_waitcnt lgkmcnt(10)
    v_mfma_f32_16x16x32_bf16 v[48:51], v[112:115], v[176:179], v[48:51]
    ds_read_b128 v[140:143], v21 offset:0
    v_mfma_f32_16x16x32_bf16 v[52:55], v[112:115], v[180:183], v[52:55]
    ds_read_b128 v[144:147], v21 offset:2048
    s_waitcnt lgkmcnt(11)
    v_mfma_f32_16x16x32_bf16 v[56:59], v[116:119], v[176:179], v[56:59]
    ds_read_b128 v[148:151], v21 offset:4096
    v_mfma_f32_16x16x32_bf16 v[60:63], v[116:119], v[180:183], v[60:63]
    ds_read_b128 v[152:155], v21 offset:6144
    s_waitcnt lgkmcnt(12)
    v_mfma_f32_16x16x32_bf16 v[64:67], v[120:123], v[176:179], v[64:67]
    ds_read_b128 v[156:159], v21 offset:8192
    v_mfma_f32_16x16x32_bf16 v[68:71], v[120:123], v[180:183], v[68:71]
    ds_read_b128 v[160:163], v21 offset:10240
    s_waitcnt lgkmcnt(13)
    v_mfma_f32_16x16x32_bf16 v[72:75], v[124:127], v[176:179], v[72:75]
    ds_read_b128 v[164:167], v21 offset:12288
    v_mfma_f32_16x16x32_bf16 v[76:79], v[124:127], v[180:183], v[76:79]
    ds_read_b128 v[168:171], v21 offset:14336
    s_waitcnt lgkmcnt(14)
    v_mfma_f32_16x16x32_bf16 v[80:83], v[128:131], v[176:179], v[80:83]
    ds_read_b128 v[172:175], v21 offset:32768
    v_mfma_f32_16x16x32_bf16 v[84:87], v[128:131], v[180:183], v[84:87]
    v_perm_b32 v217, v239, v235, s60
    s_waitcnt lgkmcnt(14)
    v_mfma_f32_16x16x32_bf16 v[88:91], v[132:135], v[176:179], v[88:91]
    v_perm_b32 v218, v247, v243, s60
    v_mfma_f32_16x16x32_bf16 v[92:95], v[132:135], v[180:183], v[92:95]
    v_perm_b32 v219, v255, v251, s60
    s_waitcnt lgkmcnt(13)
    v_mfma_f32_16x16x32_bf16 v[96:99], v[136:139], v[176:179], v[96:99]
    v_perm_b32 v220, v231, v227, s61
    v_mfma_f32_16x16x32_bf16 v[100:103], v[136:139], v[180:183], v[100:103]
    v_perm_b32 v221, v239, v235, s61
    s_waitcnt vmcnt(6) lgkmcnt(0)
    s_barrier
    s_xor_b32 s52, s92, 7
    s_add_u32 s52, s47, s52
    s_and_b32 s52, s52, 7
    s_lshl_b32 s53, s52, 17
    s_lshl_b32 s52, s52, 7
    s_add_u32 s54, s53, 1024
    s_add_u32 m0, s56, 50176
    s_nop 0
    buffer_load_dwordx4 v15, s[24:27], s53 offen lds
    s_add_u32 m0, s56, 58368
    s_nop 0
    buffer_load_dwordx4 v15, s[24:27], s54 offen lds
    s_add_u32 m0, s57, 50176
    s_nop 0
    buffer_load_dwordx4 v10, s[20:23], s52 offen lds
    s_add_u32 m0, s57, 51200
    s_nop 0
    buffer_load_dwordx4 v11, s[20:23], s52 offen lds
    s_add_u32 m0, s57, 52224
    s_nop 0
    buffer_load_dwordx4 v12, s[20:23], s52 offen lds
    s_add_u32 m0, s57, 53248
    s_nop 0
    buffer_load_dwordx4 v13, s[20:23], s52 offen lds
    v_mfma_f32_16x16x32_bf16 v[32:35], v[140:143], v[184:187], v[32:35]
    ds_read_b64_tr_b16 v[176:177], v26 offset:0
    v_mfma_f32_16x16x32_bf16 v[36:39], v[140:143], v[188:191], v[36:39]
    ds_read_b64_tr_b16 v[178:179], v26 offset:512
    v_mfma_f32_16x16x32_bf16 v[40:43], v[144:147], v[184:187], v[40:43]
    ds_read_b64_tr_b16 v[180:181], v26 offset:8192
    v_mfma_f32_16x16x32_bf16 v[44:47], v[144:147], v[188:191], v[44:47]
    ds_read_b64_tr_b16 v[182:183], v26 offset:8704
    v_mfma_f32_16x16x32_bf16 v[48:51], v[148:151], v[184:187], v[48:51]
    ds_read_b128 v[104:107], v22 offset:0
    v_mfma_f32_16x16x32_bf16 v[52:55], v[148:151], v[188:191], v[52:55]
    ds_read_b128 v[108:111], v22 offset:2048
    v_mfma_f32_16x16x32_bf16 v[56:59], v[152:155], v[184:187], v[56:59]
    ds_read_b128 v[112:115], v22 offset:4096
    v_mfma_f32_16x16x32_bf16 v[60:63], v[152:155], v[188:191], v[60:63]
    ds_read_b128 v[116:119], v22 offset:6144
    v_mfma_f32_16x16x32_bf16 v[64:67], v[156:159], v[184:187], v[64:67]
    ds_read_b128 v[120:123], v22 offset:8192
    v_mfma_f32_16x16x32_bf16 v[68:71], v[156:159], v[188:191], v[68:71]
    ds_read_b128 v[124:127], v22 offset:10240
    v_mfma_f32_16x16x32_bf16 v[72:75], v[160:163], v[184:187], v[72:75]
    ds_read_b128 v[128:131], v22 offset:12288
    v_mfma_f32_16x16x32_bf16 v[76:79], v[160:163], v[188:191], v[76:79]
    ds_read_b128 v[132:135], v22 offset:14336
    v_mfma_f32_16x16x32_bf16 v[80:83], v[164:167], v[184:187], v[80:83]
    ds_read_b128 v[136:139], v22 offset:32768
    v_mfma_f32_16x16x32_bf16 v[84:87], v[164:167], v[188:191], v[84:87]
    v_perm_b32 v222, v247, v243, s61
    v_mfma_f32_16x16x32_bf16 v[88:91], v[168:171], v[184:187], v[88:91]
    v_perm_b32 v223, v255, v251, s61
    v_mfma_f32_16x16x32_bf16 v[92:95], v[168:171], v[188:191], v[92:95]
    v_mfma_f32_16x16x32_bf16 v[96:99], v[172:175], v[184:187], v[96:99]
    v_mfma_f32_16x16x32_bf16 v[100:103], v[172:175], v[188:191], v[100:103]
    s_waitcnt lgkmcnt(8)
    v_mfma_f32_16x16x32_bf16 v[32:35], v[104:107], v[176:179], v[32:35]
    ds_read_b64_tr_b16 v[184:185], v26 offset:4096
    v_mfma_f32_16x16x32_bf16 v[36:39], v[104:107], v[180:183], v[36:39]
    ds_read_b64_tr_b16 v[186:187], v26 offset:4608
    s_waitcnt lgkmcnt(9)
    v_mfma_f32_16x16x32_bf16 v[40:43], v[108:111], v[176:179], v[40:43]
    ds_read_b64_tr_b16 v[188:189], v26 offset:12288
    v_mfma_f32_16x16x32_bf16 v[44:47], v[108:111], v[180:183], v[44:47]
    ds_read_b64_tr_b16 v[190:191], v26 offset:12800
    s_waitcnt lgkmcnt(10)
    v_mfma_f32_16x16x32_bf16 v[48:51], v[112:115], v[176:179], v[48:51]
    ds_read_b128 v[140:143], v23 offset:0
    v_mfma_f32_16x16x32_bf16 v[52:55], v[112:115], v[180:183], v[52:55]
    ds_read_b128 v[144:147], v23 offset:2048
    s_waitcnt lgkmcnt(11)
    v_mfma_f32_16x16x32_bf16 v[56:59], v[116:119], v[176:179], v[56:59]
    ds_read_b128 v[148:151], v23 offset:4096
    v_mfma_f32_16x16x32_bf16 v[60:63], v[116:119], v[180:183], v[60:63]
    ds_read_b128 v[152:155], v23 offset:6144
    s_waitcnt lgkmcnt(12)
    v_mfma_f32_16x16x32_bf16 v[64:67], v[120:123], v[176:179], v[64:67]
    ds_read_b128 v[156:159], v23 offset:8192
    v_mfma_f32_16x16x32_bf16 v[68:71], v[120:123], v[180:183], v[68:71]
    ds_read_b128 v[160:163], v23 offset:10240
    s_waitcnt lgkmcnt(13)
    v_mfma_f32_16x16x32_bf16 v[72:75], v[124:127], v[176:179], v[72:75]
    ds_read_b128 v[164:167], v23 offset:12288
    v_mfma_f32_16x16x32_bf16 v[76:79], v[124:127], v[180:183], v[76:79]
    ds_read_b128 v[168:171], v23 offset:14336
    s_waitcnt lgkmcnt(14)
    v_mfma_f32_16x16x32_bf16 v[80:83], v[128:131], v[176:179], v[80:83]
    ds_read_b128 v[172:175], v23 offset:32768
    v_mfma_f32_16x16x32_bf16 v[84:87], v[128:131], v[180:183], v[84:87]
    s_waitcnt lgkmcnt(14)
    v_mfma_f32_16x16x32_bf16 v[88:91], v[132:135], v[176:179], v[88:91]
    v_mfma_f32_16x16x32_bf16 v[92:95], v[132:135], v[180:183], v[92:95]
    s_waitcnt lgkmcnt(13)
    v_mfma_f32_16x16x32_bf16 v[96:99], v[136:139], v[176:179], v[96:99]
    v_mfma_f32_16x16x32_bf16 v[100:103], v[136:139], v[180:183], v[100:103]
    s_waitcnt vmcnt(6) lgkmcnt(0)
    s_barrier
    global_load_dwordx2 v[30:31], v28, s[14:15] sc1
    s_lshl_b32 s57, s48, 10
    s_add_u32 s90, s46, 0
    s_and_b32 s90, s90, 7
    s_lshl_b32 s90, s90, 16
    s_add_u32 s91, s90, 128
    s_add_u32 m0, s57, 137216
    s_nop 0
    buffer_load_dwordx4 v27, s[40:43], s90 offen lds
    s_add_u32 m0, s57, 141312
    s_nop 0
    buffer_load_dwordx4 v27, s[40:43], s91 offen lds
    s_add_u32 s90, s46, 1
    s_and_b32 s90, s90, 7
    s_lshl_b32 s90, s90, 16
    s_add_u32 s91, s90, 128
    s_add_u32 m0, s57, 145408
    s_nop 0
    buffer_load_dwordx4 v27, s[40:43], s90 offen lds
    s_add_u32 m0, s57, 149504
    s_nop 0
    buffer_load_dwordx4 v27, s[40:43], s91 offen lds
    s_cmp_lt_u32 s48, 2
    s_cbranch_scc0 L_nopf_W2all
    s_lshr_b32 s52, s2, 3
    s_lshl_b32 s52, s52, 1
    s_add_u32 s52, s52, s48
    s_lshl_b32 s52, s52, 13
    v_lshlrev_b32 v5, 7, v1
    buffer_load_dword v2, v5, s[40:43], s52 offen
L_nopf_W2all:
    s_lshl_b32 s54, s46, 3
    s_add_u32 s54, s54, s44
    s_lshl_b32 s54, s54, 9
    s_lshl_b32 s55, s45, 18
    s_add_u32 s54, s54, s55
    v_lshrrev_b32 v5, 2, v1
    v_and_b32 v5, 7, v5
    v_lshlrev_b32 v5, 15, v5
    v_and_b32 v6, 3, v1
    v_lshl_add_u32 v5, v6, 7, v5
    v_lshrrev_b32 v6, 5, v1
    v_lshl_add_u32 v5, v6, 11, v5
    buffer_load_dword v2, v5, s[36:39], s54 offen
    s_mov_b64 exec, 15
    s_lshl_b32 s54, s45, 9
    s_add_u32 s54, s54, 8388608
    buffer_load_dword v2, v5, s[36:39], s54 offen
    s_mov_b64 exec, -1
    s_waitcnt vmcnt(7)
    s_barrier
    s_setprio 1
    v_mfma_f32_16x16x32_bf16 v[32:35], v[140:143], v[184:187], v[32:35]
    ds_read_b64_tr_b16 v[176:177], v24 offset:0
    v_mfma_f32_16x16x32_bf16 v[36:39], v[140:143], v[188:191], v[36:39]
    ds_read_b64_tr_b16 v[178:179], v24 offset:512
    v_mfma_f32_16x16x32_bf16 v[40:43], v[144:147], v[184:187], v[40:43]
    ds_read_b64_tr_b16 v[180:181], v24 offset:8192
    v_mfma_f32_16x16x32_bf16 v[44:47], v[144:147], v[188:191], v[44:47]
    ds_read_b64_tr_b16 v[182:183], v24 offset:8704
    v_mfma_f32_16x16x32_bf16 v[48:51], v[148:151], v[184:187], v[48:51]
    ds_read_b128 v[104:107], v18 offset:0
    v_mfma_f32_16x16x32_bf16 v[52:55], v[148:151], v[188:191], v[52:55]
    ds_read_b128 v[108:111], v18 offset:2048
    v_mfma_f32_16x16x32_bf16 v[56:59], v[152:155], v[184:187], v[56:59]
    ds_read_b128 v[112:115], v18 offset:4096
    v_mfma_f32_16x16x32_bf16 v[60:63], v[152:155], v[188:191], v[60:63]
    ds_read_b128 v[116:119], v18 offset:6144
    v_mfma_f32_16x16x32_bf16 v[64:67], v[156:159], v[184:187], v[64:67]
    ds_read_b128 v[120:123], v18 offset:8192
    v_mfma_f32_16x16x32_bf16 v[68:71], v[156:159], v[188:191], v[68:71]
    ds_read_b128 v[124:127], v18 offset:10240
    v_mfma_f32_16x16x32_bf16 v[72:75], v[160:163], v[184:187], v[72:75]
    ds_read_b128 v[128:131], v18 offset:12288
    v_mfma_f32_16x16x32_bf16 v[76:79], v[160:163], v[188:191], v[76:79]
    ds_read_b128 v[132:135], v18 offset:14336
    v_mfma_f32_16x16x32_bf16 v[80:83], v[164:167], v[184:187], v[80:83]
    ds_read_b128 v[136:139], v18 offset:32768
    v_mfma_f32_16x16x32_bf16 v[84:87], v[164:167], v[188:191], v[84:87]
    v_mfma_f32_16x16x32_bf16 v[88:91], v[168:171], v[184:187], v[88:91]
    v_mfma_f32_16x16x32_bf16 v[92:95], v[168:171], v[188:191], v[92:95]
    v_mfma_f32_16x16x32_bf16 v[96:99], v[172:175], v[184:187], v[96:99]
    v_mfma_f32_16x16x32_bf16 v[100:103], v[172:175], v[188:191], v[100:103]
    s_waitcnt lgkmcnt(8)
    v_mfma_f32_16x16x32_bf16 v[32:35], v[104:107], v[176:179], v[32:35]
    ds_read_b64_tr_b16 v[184:185], v24 offset:4096
    v_mfma_f32_16x16x32_bf16 v[36:39], v[104:107], v[180:183], v[36:39]
    ds_read_b64_tr_b16 v[186:187], v24 offset:4608
    s_waitcnt lgkmcnt(9)
    v_mfma_f32_16x16x32_bf16 v[40:43], v[108:111], v[176:179], v[40:43]
    ds_read_b64_tr_b16 v[188:189], v24 offset:12288
    v_mfma_f32_16x16x32_bf16 v[44:47], v[108:111], v[180:183], v[44:47]
    ds_read_b64_tr_b16 v[190:191], v24 offset:12800
    s_waitcnt lgkmcnt(10)
    v_mfma_f32_16x16x32_bf16 v[48:51], v[112:115], v[176:179], v[48:51]
    ds_read_b128 v[140:143], v19 offset:0
    v_mfma_f32_16x16x32_bf16 v[52:55], v[112:115], v[180:183], v[52:55]
    ds_read_b128 v[144:147], v19 offset:2048
    s_waitcnt lgkmcnt(11)
    v_mfma_f32_16x16x32_bf16 v[56:59], v[116:119], v[176:179], v[56:59]
    ds_read_b128 v[148:151], v19 offset:4096
    v_mfma_f32_16x16x32_bf16 v[60:63], v[116:119], v[180:183], v[60:63]
    ds_read_b128 v[152:155], v19 offset:6144
    s_waitcnt lgkmcnt(12)
    v_mfma_f32_16x16x32_bf16 v[64:67], v[120:123], v[176:179], v[64:67]
    ds_read_b128 v[156:159], v19 offset:8192
    v_mfma_f32_16x16x32_bf16 v[68:71], v[120:123], v[180:183], v[68:71]
    ds_read_b128 v[160:163], v19 offset:10240
    s_waitcnt lgkmcnt(13)
    v_mfma_f32_16x16x32_bf16 v[72:75], v[124:127], v[176:179], v[72:75]
    ds_read_b128 v[164:167], v19 offset:12288
    v_mfma_f32_16x16x32_bf16 v[76:79], v[124:127], v[180:183], v[76:79]
    ds_read_b128 v[168:171], v19 offset:14336
    s_waitcnt lgkmcnt(14)
    v_mfma_f32_16x16x32_bf16 v[80:83], v[128:131], v[176:179], v[80:83]
    ds_read_b128 v[172:175], v19 offset:32768
    v_mfma_f32_16x16x32_bf16 v[84:87], v[128:131], v[180:183], v[84:87]
    s_waitcnt lgkmcnt(14)
    v_mfma_f32_16x16x32_bf16 v[88:91], v[132:135], v[176:179], v[88:91]
    v_mfma_f32_16x16x32_bf16 v[92:95], v[132:135], v[180:183], v[92:95]
    s_waitcnt lgkmcnt(13)
    v_mfma_f32_16x16x32_bf16 v[96:99], v[136:139], v[176:179], v[96:99]
    v_mfma_f32_16x16x32_bf16 v[100:103], v[136:139], v[180:183], v[100:103]
    s_waitcnt lgkmcnt(8)
    v_mfma_f32_16x16x32_bf16 v[32:35], v[140:143], v[184:187], v[32:35]
    ds_read_b64_tr_b16 v[176:177], v25 offset:0
    v_mfma_f32_16x16x32_bf16 v[36:39], v[140:143], v[188:191], v[36:39]
    ds_read_b64_tr_b16 v[178:179], v25 offset:512
    s_waitcnt lgkmcnt(9)
    v_mfma_f32_16x16x32_bf16 v[40:43], v[144:147], v[184:187], v[40:43]
    ds_read_b64_tr_b16 v[180:181], v25 offset:8192
    v_mfma_f32_16x16x32_bf16 v[44:47], v[144:147], v[188:191], v[44:47]
    ds_read_b64_tr_b16 v[182:183], v25 offset:8704
    s_waitcnt lgkmcnt(10)
    v_mfma_f32_16x16x32_bf16 v[48:51], v[148:151], v[184:187], v[48:51]
    ds_read_b128 v[104:107], v20 offset:0
    v_mfma_f32_16x16x32_bf16 v[52:55], v[148:151], v[188:191], v[52:55]
    ds_read_b128 v[108:111], v20 offset:2048
    s_waitcnt lgkmcnt(11)
    v_mfma_f32_16x16x32_bf16 v[56:59], v[152:155], v[184:187], v[56:59]
    ds_read_b128 v[112:115], v20 offset:4096
    v_mfma_f32_16x16x32_bf16 v[60:63], v[152:155], v[188:191], v[60:63]
    ds_read_b128 v[116:119], v20 offset:6144
    s_waitcnt lgkmcnt(12)
    v_mfma_f32_16x16x32_bf16 v[64:67], v[156:159], v[184:187], v[64:67]
    ds_read_b128 v[120:123], v20 offset:8192
    v_mfma_f32_16x16x32_bf16 v[68:71], v[156:159], v[188:191], v[68:71]
    ds_read_b128 v[124:127], v20 offset:10240
    s_waitcnt lgkmcnt(13)
    v_mfma_f32_16x16x32_bf16 v[72:75], v[160:163], v[184:187], v[72:75]
    ds_read_b128 v[128:131], v20 offset:12288
    v_mfma_f32_16x16x32_bf16 v[76:79], v[160:163], v[188:191], v[76:79]
    ds_read_b128 v[132:135], v20 offset:14336
    s_waitcnt lgkmcnt(14)
    v_mfma_f32_16x16x32_bf16 v[80:83], v[164:167], v[184:187], v[80:83]
    ds_read_b128 v[136:139], v20 offset:32768
    v_mfma_f32_16x16x32_bf16 v[84:87], v[164:167], v[188:191], v[84:87]
    s_waitcnt lgkmcnt(14)
    v_mfma_f32_16x16x32_bf16 v[88:91], v[168:171], v[184:187], v[88:91]
    v_mfma_f32_16x16x32_bf16 v[92:95], v[168:171], v[188:191], v[92:95]
    s_waitcnt lgkmcnt(13)
    v_mfma_f32_16x16x32_bf16 v[96:99], v[172:175], v[184:187], v[96:99]
    v_mfma_f32_16x16x32_bf16 v[100:103], v[172:175], v[188:191], v[100:103]
    s_waitcnt lgkmcnt(8)
    v_mfma_f32_16x16x32_bf16 v[32:35], v[104:107], v[176:179], v[32:35]
    ds_read_b64_tr_b16 v[184:185], v25 offset:4096
    v_mfma_f32_16x16x32_bf16 v[36:39], v[104:107], v[180:183], v[36:39]
    ds_read_b64_tr_b16 v[186:187], v25 offset:4608
    s_waitcnt lgkmcnt(9)
    v_mfma_f32_16x16x32_bf16 v[40:43], v[108:111], v[176:179], v[40:43]
    ds_read_b64_tr_b16 v[188:189], v25 offset:12288
    v_mfma_f32_16x16x32_bf16 v[44:47], v[108:111], v[180:183], v[44:47]
    ds_read_b64_tr_b16 v[190:191], v25 offset:12800
    s_waitcnt lgkmcnt(10)
    v_mfma_f32_16x16x32_bf16 v[48:51], v[112:115], v[176:179], v[48:51]
    ds_read_b128 v[140:143], v21 offset:0
    v_mfma_f32_16x16x32_bf16 v[52:55], v[112:115], v[180:183], v[52:55]
    ds_read_b128 v[144:147], v21 offset:2048
    s_waitcnt lgkmcnt(11)
    v_mfma_f32_16x16x32_bf16 v[56:59], v[116:119], v[176:179], v[56:59]
    ds_read_b128 v[148:151], v21 offset:4096
    v_mfma_f32_16x16x32_bf16 v[60:63], v[116:119], v[180:183], v[60:63]
    ds_read_b128 v[152:155], v21 offset:6144
    s_waitcnt lgkmcnt(12)
    v_mfma_f32_16x16x32_bf16 v[64:67], v[120:123], v[176:179], v[64:67]
    ds_read_b128 v[156:159], v21 offset:8192
    v_mfma_f32_16x16x32_bf16 v[68:71], v[120:123], v[180:183], v[68:71]
    ds_read_b128 v[160:163], v21 offset:10240
    s_waitcnt lgkmcnt(13)
    v_mfma_f32_16x16x32_bf16 v[72:75], v[124:127], v[176:179], v[72:75]
    ds_read_b128 v[164:167], v21 offset:12288
    v_mfma_f32_16x16x32_bf16 v[76:79], v[124:127], v[180:183], v[76:79]
    ds_read_b128 v[168:171], v21 offset:14336
    s_waitcnt lgkmcnt(14)
    v_mfma_f32_16x16x32_bf16 v[80:83], v[128:131], v[176:179], v[80:83]
    ds_read_b128 v[172:175], v21 offset:32768
    v_mfma_f32_16x16x32_bf16 v[84:87], v[128:131], v[180:183], v[84:87]
    s_waitcnt lgkmcnt(14)
    v_mfma_f32_16x16x32_bf16 v[88:91], v[132:135], v[176:179], v[88:91]
    v_mfma_f32_16x16x32_bf16 v[92:95], v[132:135], v[180:183], v[92:95]
    s_waitcnt lgkmcnt(13)
    v_mfma_f32_16x16x32_bf16 v[96:99], v[136:139], v[176:179], v[96:99]
    v_mfma_f32_16x16x32_bf16 v[100:103], v[136:139], v[180:183], v[100:103]
    s_waitcnt lgkmcnt(8)
    v_mfma_f32_16x16x32_bf16 v[32:35], v[140:143], v[184:187], v[32:35]
    v_mfma_f32_16x16x32_bf16 v[36:39], v[140:143], v[188:191], v[36:39]
    s_waitcnt lgkmcnt(7)
    v_mfma_f32_16x16x32_bf16 v[40:43], v[144:147], v[184:187], v[40:43]
    v_mfma_f32_16x16x32_bf16 v[44:47], v[144:147], v[188:191], v[44:47]
    s_waitcnt lgkmcnt(6)
    v_mfma_f32_16x16x32_bf16 v[48:51], v[148:151], v[184:187], v[48:51]
    v_mfma_f32_16x16x32_bf16 v[52:55], v[148:151], v[188:191], v[52:55]
    s_waitcnt lgkmcnt(5)
    v_mfma_f32_16x16x32_bf16 v[56:59], v[152:155], v[184:187], v[56:59]
    v_mfma_f32_16x16x32_bf16 v[60:63], v[152:155], v[188:191], v[60:63]
    s_waitcnt lgkmcnt(4)
    v_mfma_f32_16x16x32_bf16 v[64:67], v[156:159], v[184:187], v[64:67]
    v_mfma_f32_16x16x32_bf16 v[68:71], v[156:159], v[188:191], v[68:71]
    s_waitcnt lgkmcnt(3)
    v_mfma_f32_16x16x32_bf16 v[72:75], v[160:163], v[184:187], v[72:75]
    v_mfma_f32_16x16x32_bf16 v[76:79], v[160:163], v[188:191], v[76:79]
    s_waitcnt lgkmcnt(2)
    v_mfma_f32_16x16x32_bf16 v[80:83], v[164:167], v[184:187], v[80:83]
    v_mfma_f32_16x16x32_bf16 v[84:87], v[164:167], v[188:191], v[84:87]
    s_waitcnt lgkmcnt(1)
    v_mfma_f32_16x16x32_bf16 v[88:91], v[168:171], v[184:187], v[88:91]
    v_mfma_f32_16x16x32_bf16 v[92:95], v[168:171], v[188:191], v[92:95]
    s_waitcnt lgkmcnt(0)
    v_mfma_f32_16x16x32_bf16 v[96:99], v[172:175], v[184:187], v[96:99]
    v_mfma_f32_16x16x32_bf16 v[100:103], v[172:175], v[188:191], v[100:103]
    s_setprio 0
    s_lshl_b32 s52, s48, 4
    v_add_u32 v5, s52, v3
    v_mul_u32_u24 v5, 560, v5
    v_add_u32 v5, 100352, v5
    v_lshl_add_u32 v6, v4, 4, v5
    v_lshl_add_u32 v7, v4, 3, v5
    s_nop 1
    v_pk_mul_f32 v[104:105], v[36:37], s[64:65]
    v_pk_mul_f32 v[106:107], v[38:39], s[64:65]
    v_pk_mul_f32 v[108:109], v[44:45], s[64:65]
    v_pk_mul_f32 v[110:111], v[46:47], s[64:65]
    v_exp_f32 v104, v104
    v_exp_f32 v105, v105
    v_exp_f32 v106, v106
    v_exp_f32 v107, v107
    v_exp_f32 v108, v108
    v_exp_f32 v109, v109
    v_exp_f32 v110, v110
    v_exp_f32 v111, v111
    v_pk_add_f32 v[104:105], v[104:105], 1.0 op_sel_hi:[1,0]
    v_pk_add_f32 v[106:107], v[106:107], 1.0 op_sel_hi:[1,0]
    v_pk_add_f32 v[108:109], v[108:109], 1.0 op_sel_hi:[1,0]
    v_pk_add_f32 v[110:111], v[110:111], 1.0 op_sel_hi:[1,0]
    v_rcp_f32 v104, v104
    v_rcp_f32 v105, v105
    v_rcp_f32 v106, v106
    v_rcp_f32 v107, v107
    v_rcp_f32 v108, v108
    v_rcp_f32 v109, v109
    v_rcp_f32 v110, v110
    v_rcp_f32 v111, v111
    v_pk_mul_f32 v[104:105], v[32:33], v[104:105]
    v_pk_mul_f32 v[106:107], v[34:35], v[106:107]
    v_pk_mul_f32 v[108:109], v[40:41], v[108:109]
    v_pk_mul_f32 v[110:111], v[42:43], v[110:111]
    v_cvt_pk_bf16_f32 v112, v104, v105
    v_cvt_pk_bf16_f32 v113, v106, v107
    v_cvt_pk_bf16_f32 v114, v108, v109
    v_cvt_pk_bf16_f32 v115, v110, v111
    ds_write_b128 v6, v[112:115] offset:0
    v_pk_mul_f32 v[104:105], v[52:53], s[64:65]
    v_pk_mul_f32 v[106:107], v[54:55], s[64:65]
    v_pk_mul_f32 v[108:109], v[60:61], s[64:65]
    v_pk_mul_f32 v[110:111], v[62:63], s[64:65]
    v_exp_f32 v104, v104
    v_exp_f32 v105, v105
    v_exp_f32 v106, v106
    v_exp_f32 v107, v107
    v_exp_f32 v108, v108
    v_exp_f32 v109, v109
    v_exp_f32 v110, v110
    v_exp_f32 v111, v111
    v_pk_add_f32 v[104:105], v[104:105], 1.0 op_sel_hi:[1,0]
    v_pk_add_f32 v[106:107], v[106:107], 1.0 op_sel_hi:[1,0]
    v_pk_add_f32 v[108:109], v[108:109], 1.0 op_sel_hi:[1,0]
    v_pk_add_f32 v[110:111], v[110:111], 1.0 op_sel_hi:[1,0]
    v_rcp_f32 v104, v104
    v_rcp_f32 v105, v105
    v_rcp_f32 v106, v106
    v_rcp_f32 v107, v107
    v_rcp_f32 v108, v108
    v_rcp_f32 v109, v109
    v_rcp_f32 v110, v110
    v_rcp_f32 v111, v111
    v_pk_mul_f32 v[104:105], v[48:49], v[104:105]
    v_pk_mul_f32 v[106:107], v[50:51], v[106:107]
    v_pk_mul_f32 v[108:109], v[56:57], v[108:109]
    v_pk_mul_f32 v[110:111], v[58:59], v[110:111]
    v_cvt_pk_bf16_f32 v116, v104, v105
    v_cvt_pk_bf16_f32 v117, v106, v107
    v_cvt_pk_bf16_f32 v118, v108, v109
    v_cvt_pk_bf16_f32 v119, v110, v111
    ds_write_b128 v6, v[116:119] offset:64
    v_pk_mul_f32 v[104:105], v[68:69], s[64:65]
    v_pk_mul_f32 v[106:107], v[70:71], s[64:65]
    v_pk_mul_f32 v[108:109], v[76:77], s[64:65]
    v_pk_mul_f32 v[110:111], v[78:79], s[64:65]
    v_exp_f32 v104, v104
    v_exp_f32 v105, v105
    v_exp_f32 v106, v106
    v_exp_f32 v107, v107
    v_exp_f32 v108, v108
    v_exp_f32 v109, v109
    v_exp_f32 v110, v110
    v_exp_f32 v111, v111
    v_pk_add_f32 v[104:105], v[104:105], 1.0 op_sel_hi:[1,0]
    v_pk_add_f32 v[106:107], v[106:107], 1.0 op_sel_hi:[1,0]
    v_pk_add_f32 v[108:109], v[108:109], 1.0 op_sel_hi:[1,0]
    v_pk_add_f32 v[110:111], v[110:111], 1.0 op_sel_hi:[1,0]
    v_rcp_f32 v104, v104
    v_rcp_f32 v105, v105
    v_rcp_f32 v106, v106
    v_rcp_f32 v107, v107
    v_rcp_f32 v108, v108
    v_rcp_f32 v109, v109
    v_rcp_f32 v110, v110
    v_rcp_f32 v111, v111
    v_pk_mul_f32 v[104:105], v[64:65], v[104:105]
    v_pk_mul_f32 v[106:107], v[66:67], v[106:107]
    v_pk_mul_f32 v[108:109], v[72:73], v[108:109]
    v_pk_mul_f32 v[110:111], v[74:75], v[110:111]
    v_cvt_pk_bf16_f32 v112, v104, v105
    v_cvt_pk_bf16_f32 v113, v106, v107
    v_cvt_pk_bf16_f32 v114, v108, v109
    v_cvt_pk_bf16_f32 v115, v110, v111
    ds_write_b128 v6, v[112:115] offset:128
    v_pk_mul_f32 v[104:105], v[84:85], s[64:65]
    v_pk_mul_f32 v[106:107], v[86:87], s[64:65]
    v_pk_mul_f32 v[108:109], v[92:93], s[64:65]
    v_pk_mul_f32 v[110:111], v[94:95], s[64:65]
    v_exp_f32 v104, v104
    v_exp_f32 v105, v105
    v_exp_f32 v106, v106
    v_exp_f32 v107, v107
    v_exp_f32 v108, v108
    v_exp_f32 v109, v109
    v_exp_f32 v110, v110
    v_exp_f32 v111, v111
    v_pk_add_f32 v[104:105], v[104:105], 1.0 op_sel_hi:[1,0]
    v_pk_add_f32 v[106:107], v[106:107], 1.0 op_sel_hi:[1,0]
    v_pk_add_f32 v[108:109], v[108:109], 1.0 op_sel_hi:[1,0]
    v_pk_add_f32 v[110:111], v[110:111], 1.0 op_sel_hi:[1,0]
    v_rcp_f32 v104, v104
    v_rcp_f32 v105, v105
    v_rcp_f32 v106, v106
    v_rcp_f32 v107, v107
    v_rcp_f32 v108, v108
    v_rcp_f32 v109, v109
    v_rcp_f32 v110, v110
    v_rcp_f32 v111, v111
    v_pk_mul_f32 v[104:105], v[80:81], v[104:105]
    v_pk_mul_f32 v[106:107], v[82:83], v[106:107]
    v_pk_mul_f32 v[108:109], v[88:89], v[108:109]
    v_pk_mul_f32 v[110:111], v[90:91], v[110:111]
    v_cvt_pk_bf16_f32 v116, v104, v105
    v_cvt_pk_bf16_f32 v117, v106, v107
    v_cvt_pk_bf16_f32 v118, v108, v109
    v_cvt_pk_bf16_f32 v119, v110, v111
    ds_write_b128 v6, v[116:119] offset:192
    v_cmp_gt_u32 vcc, 2, v4
    v_pk_mul_f32 v[104:105], v[100:101], s[64:65]
    v_pk_mul_f32 v[106:107], v[102:103], s[64:65]
    v_exp_f32 v104, v104
    v_exp_f32 v105, v105
    v_exp_f32 v106, v106
    v_exp_f32 v107, v107
    v_pk_add_f32 v[104:105], v[104:105], 1.0 op_sel_hi:[1,0]
    v_pk_add_f32 v[106:107], v[106:107], 1.0 op_sel_hi:[1,0]
    v_rcp_f32 v104, v104
    v_rcp_f32 v105, v105
    v_rcp_f32 v106, v106
    v_rcp_f32 v107, v107
    v_pk_mul_f32 v[104:105], v[96:97], v[104:105]
    v_pk_mul_f32 v[106:107], v[98:99], v[106:107]
    v_cvt_pk_bf16_f32 v120, v104, v105
    v_cvt_pk_bf16_f32 v121, v106, v107
    v_cndmask_b32 v120, 0, v120, vcc
    v_cndmask_b32 v121, 0, v121, vcc
    ds_write_b64 v7, v[120:121] offset:512
    s_waitcnt vmcnt(2)
    s_mul_i32 s52, s44, 4480
    s_add_u32 s52, s52, 100352
    v_lshlrev_b32 v5, 5, v3
    v_lshl_add_u32 v5, v4, 4, v5
    v_add_u32 v5, s52, v5
    s_lshl_b32 s54, s46, 3
    s_add_u32 s54, s54, s44
    s_lshl_b32 s53, s54, 3
    v_mov_b32 v11, s53
    s_lshl_b32 s54, s54, 9
    s_lshl_b32 s55, s45, 18
    s_add_u32 s54, s54, s55
    v_lshlrev_b32 v6, 16, v4
    v_lshl_add_u32 v6, v3, 4, v6
    v_add_u32 v7, 0x8000, v6
    s_lshl_b32 s55, s45, 9
    s_add_u32 s55, s55, 8388608
    s_lshl_b32 s57, s48, 10
    v_mov_b32 v14, 155136
    v_mov_b32 v15, 1
    s_waitcnt lgkmcnt(0)
    s_barrier
    ds_read_b128 v[32:35], v5 offset:0
    ds_read_b128 v[36:39], v5 offset:560
    ds_read_b128 v[40:43], v5 offset:1120
    ds_read_b128 v[44:47], v5 offset:1680
    ds_read_b128 v[48:51], v5 offset:2240
    ds_read_b128 v[52:55], v5 offset:2800
    ds_read_b128 v[56:59], v5 offset:3360
    ds_read_b128 v[60:63], v5 offset:3920
    s_setprio 2
    s_waitcnt lgkmcnt(7)
    v_mfma_f32_16x16x32_bf16 v[64:67], v[32:35], v[192:195], 0
    s_waitcnt lgkmcnt(6)
    v_mfma_f32_16x16x32_bf16 v[68:71], v[36:39], v[196:199], 0
    s_waitcnt lgkmcnt(5)
    v_mfma_f32_16x16x32_bf16 v[72:75], v[40:43], v[200:203], 0
    s_waitcnt lgkmcnt(4)
    v_mfma_f32_16x16x32_bf16 v[76:79], v[44:47], v[204:207], 0
    s_waitcnt lgkmcnt(3)
    v_mfma_f32_16x16x32_bf16 v[80:83], v[48:51], v[208:211], 0
    s_waitcnt lgkmcnt(2)
    v_mfma_f32_16x16x32_bf16 v[84:87], v[52:55], v[212:215], 0
    s_waitcnt lgkmcnt(1)
    v_mfma_f32_16x16x32_bf16 v[88:91], v[56:59], v[216:219], 0
    s_waitcnt lgkmcnt(0)
    v_mfma_f32_16x16x32_bf16 v[92:95], v[60:63], v[220:223], 0
    s_waitcnt vmcnt(3)
    v_readfirstlane_b32 s58, v30
    v_readfirstlane_b32 s63, v31
    s_lshl_b32 s52, 8, s49
    s_cmp_eq_u32 s63, s52
    s_cselect_b32 s63, 1, 0
    s_nop 2
    v_pk_mul_f32 v[96:97], v[64:65], s[64:65]
    v_pk_mul_f32 v[98:99], v[68:69], s[64:65]
    v_pk_mul_f32 v[100:101], v[72:73], s[64:65]
    v_pk_mul_f32 v[102:103], v[76:77], s[64:65]
    v_pk_mul_f32 v[104:105], v[80:81], s[64:65]
    v_pk_mul_f32 v[106:107], v[84:85], s[64:65]
    v_pk_mul_f32 v[108:109], v[88:89], s[64:65]
    v_pk_mul_f32 v[110:111], v[92:93], s[64:65]
    v_exp_f32 v96, v96
    v_exp_f32 v97, v97
    v_exp_f32 v98, v98
    v_exp_f32 v99, v99
    v_exp_f32 v100, v100
    v_exp_f32 v101, v101
    v_exp_f32 v102, v102
    v_exp_f32 v103, v103
    v_exp_f32 v104, v104
    v_exp_f32 v105, v105
    v_exp_f32 v106, v106
    v_exp_f32 v107, v107
    v_exp_f32 v108, v108
    v_exp_f32 v109, v109
    v_exp_f32 v110, v110
    v_exp_f32 v111, v111
    v_pk_add_f32 v[96:97], v[96:97], 1.0 op_sel_hi:[1,0]
    v_pk_add_f32 v[98:99], v[98:99], 1.0 op_sel_hi:[1,0]
    v_pk_add_f32 v[100:101], v[100:101], 1.0 op_sel_hi:[1,0]
    v_pk_add_f32 v[102:103], v[102:103], 1.0 op_sel_hi:[1,0]
    v_pk_add_f32 v[104:105], v[104:105], 1.0 op_sel_hi:[1,0]
    v_pk_add_f32 v[106:107], v[106:107], 1.0 op_sel_hi:[1,0]
    v_pk_add_f32 v[108:109], v[108:109], 1.0 op_sel_hi:[1,0]
    v_pk_add_f32 v[110:111], v[110:111], 1.0 op_sel_hi:[1,0]
    v_rcp_f32 v96, v96
    v_rcp_f32 v97, v97
    v_rcp_f32 v98, v98
    v_rcp_f32 v99, v99
    v_rcp_f32 v100, v100
    v_rcp_f32 v101, v101
    v_rcp_f32 v102, v102
    v_rcp_f32 v103, v103
    v_rcp_f32 v104, v104
    v_rcp_f32 v105, v105
    v_rcp_f32 v106, v106
    v_rcp_f32 v107, v107
    v_rcp_f32 v108, v108
    v_rcp_f32 v109, v109
    v_rcp_f32 v110, v110
    v_rcp_f32 v111, v111
    v_pk_mul_f32 v[96:97], v[64:65], v[96:97]
    v_pk_mul_f32 v[98:99], v[68:69], v[98:99]
    v_pk_mul_f32 v[100:101], v[72:73], v[100:101]
    v_pk_mul_f32 v[102:103], v[76:77], v[102:103]
    v_pk_mul_f32 v[104:105], v[80:81], v[104:105]
    v_pk_mul_f32 v[106:107], v[84:85], v[106:107]
    v_pk_mul_f32 v[108:109], v[88:89], v[108:109]
    v_pk_mul_f32 v[110:111], v[92:93], v[110:111]
    v_cvt_pk_bf16_f32 v160, v96, v98
    v_cvt_pk_bf16_f32 v161, v100, v102
    v_cvt_pk_bf16_f32 v162, v104, v106
    v_cvt_pk_bf16_f32 v163, v108, v110
    v_cvt_pk_bf16_f32 v164, v97, v99
    v_cvt_pk_bf16_f32 v165, v101, v103
    v_cvt_pk_bf16_f32 v166, v105, v107
    v_cvt_pk_bf16_f32 v167, v109, v111
    v_pk_mul_f32 v[112:113], v[66:67], s[64:65]
    v_pk_mul_f32 v[114:115], v[70:71], s[64:65]
    v_pk_mul_f32 v[116:117], v[74:75], s[64:65]
    v_pk_mul_f32 v[118:119], v[78:79], s[64:65]
    v_pk_mul_f32 v[120:121], v[82:83], s[64:65]
    v_pk_mul_f32 v[122:123], v[86:87], s[64:65]
    v_pk_mul_f32 v[124:125], v[90:91], s[64:65]
    v_pk_mul_f32 v[126:127], v[94:95], s[64:65]
    v_exp_f32 v112, v112
    v_exp_f32 v113, v113
    v_exp_f32 v114, v114
    v_exp_f32 v115, v115
    v_exp_f32 v116, v116
    v_exp_f32 v117, v117
    v_exp_f32 v118, v118
    v_exp_f32 v119, v119
    v_exp_f32 v120, v120
    v_exp_f32 v121, v121
    v_exp_f32 v122, v122
    v_exp_f32 v123, v123
    v_exp_f32 v124, v124
    v_exp_f32 v125, v125
    v_exp_f32 v126, v126
    v_exp_f32 v127, v127
    v_pk_add_f32 v[112:113], v[112:113], 1.0 op_sel_hi:[1,0]
    v_pk_add_f32 v[114:115], v[114:115], 1.0 op_sel_hi:[1,0]
    v_pk_add_f32 v[116:117], v[116:117], 1.0 op_sel_hi:[1,0]
    v_pk_add_f32 v[118:119], v[118:119], 1.0 op_sel_hi:[1,0]
    v_pk_add_f32 v[120:121], v[120:121], 1.0 op_sel_hi:[1,0]
    v_pk_add_f32 v[122:123], v[122:123], 1.0 op_sel_hi:[1,0]
    v_pk_add_f32 v[124:125], v[124:125], 1.0 op_sel_hi:[1,0]
    v_pk_add_f32 v[126:127], v[126:127], 1.0 op_sel_hi:[1,0]
    v_rcp_f32 v112, v112
    v_rcp_f32 v113, v113
    v_rcp_f32 v114, v114
    v_rcp_f32 v115, v115
    v_rcp_f32 v116, v116
    v_rcp_f32 v117, v117
    v_rcp_f32 v118, v118
    v_rcp_f32 v119, v119
    v_rcp_f32 v120, v120
    v_rcp_f32 v121, v121
    v_rcp_f32 v122, v122
    v_rcp_f32 v123, v123
    v_rcp_f32 v124, v124
    v_rcp_f32 v125, v125
    v_rcp_f32 v126, v126
    v_rcp_f32 v127, v127
    v_pk_mul_f32 v[112:113], v[66:67], v[112:113]
    v_pk_mul_f32 v[114:115], v[70:71], v[114:115]
    v_pk_mul_f32 v[116:117], v[74:75], v[116:117]
    v_pk_mul_f32 v[118:119], v[78:79], v[118:119]
    v_pk_mul_f32 v[120:121], v[82:83], v[120:121]
    v_pk_mul_f32 v[122:123], v[86:87], v[122:123]
    v_pk_mul_f32 v[124:125], v[90:91], v[124:125]
    v_pk_mul_f32 v[126:127], v[94:95], v[126:127]
    v_cvt_pk_bf16_f32 v168, v112, v114
    v_cvt_pk_bf16_f32 v169, v116, v118
    v_cvt_pk_bf16_f32 v170, v120, v122
    v_cvt_pk_bf16_f32 v171, v124, v126
    v_cvt_pk_bf16_f32 v172, v113, v115
    v_cvt_pk_bf16_f32 v173, v117, v119
    v_cvt_pk_bf16_f32 v174, v121, v123
    v_cvt_pk_bf16_f32 v175, v125, v127
    s_cmp_lg_u32 s58, 0
    s_cselect_b32 s63, s63, 0
    s_not_b32 s59, s58
    v_mov_b32 v16, s58
    v_mov_b32 v17, s59
    s_cmp_eq_u32 s63, 1
    s_cbranch_scc0 L_slow0
    buffer_store_dwordx4 v[160:163], v6, s[36:39], s54 offen offset:0 nt
    buffer_store_dwordx4 v[164:167], v6, s[36:39], s54 offen offset:256 nt
    buffer_store_dwordx4 v[168:171], v7, s[36:39], s54 offen offset:0 nt
    buffer_store_dwordx4 v[172:175], v7, s[36:39], s54 offen offset:256 nt
    s_mov_b32 s91, s55
    s_lshr_b32 s52, s46, 2
    s_lshl_b32 s52, s52, 2
    s_add_u32 s52, s52, s44
    s_lshl_b32 s90, s52, 15
    s_lshl_b32 s53, s45, 18
    s_add_u32 s53, s53, s90
    v_lshlrev_b32 v12, 4, v1
    v_add_u32 v12, s53, v12
    v_lshrrev_b32 v5, 2, v3
    v_and_b32 v8, 3, v3
    v_lshrrev_b32 v9, 1, v8
    v_and_b32 v10, 1, v4
    v_lshl_or_b32 v9, v10, 1, v9
    v_lshrrev_b32 v10, 1, v5
    v_lshlrev_b32 v10, 2, v10
    v_lshrrev_b32 v13, 1, v4
    v_lshl_or_b32 v10, v13, 1, v10
    v_xor_b32 v9, v9, v10
    v_lshlrev_b32 v9, 4, v9
    v_lshl_add_u32 v9, v5, 7, v9
    v_lshl_add_u32 v9, v13, 10, v9
    v_and_b32 v8, 1, v8
    v_lshl_add_u32 v22, v8, 3, v9
    v_xor_b32 v23, 64, v22
    v_add_u32 v24, 65536, v22
    v_add_u32 v25, 65536, v23
    v_add_u32 v26, 131072, v22
    v_add_u32 v27, 131072, v23
    s_add_u32 s52, s46, 0
    s_and_b32 s52, s52, 7
    s_lshl_b32 s20, s52, 12
    s_add_u32 s52, s46, 1
    s_and_b32 s52, s52, 7
    s_lshl_b32 s21, s52, 12
    s_add_u32 s52, s46, 2
    s_and_b32 s52, s52, 7
    s_lshl_b32 s22, s52, 12
    s_add_u32 s52, s46, 3
    s_and_b32 s52, s52, 7
    s_lshl_b32 s23, s52, 12
    s_add_u32 s52, s46, 4
    s_and_b32 s52, s52, 7
    s_lshl_b32 s24, s52, 12
    s_add_u32 s52, s46, 5
    s_and_b32 s52, s52, 7
    s_lshl_b32 s25, s52, 12
    s_add_u32 s52, s46, 6
    s_and_b32 s52, s52, 7
    s_lshl_b32 s26, s52, 12
    s_add_u32 s52, s46, 7
    s_and_b32 s52, s52, 7
    s_lshl_b32 s27, s52, 12
    s_lshl_b32 s52, s46, 3
    v_add_u32 v13, s52, v1
    v_and_b32 v13, 63, v13
    v_lshlrev_b32 v13, 3, v13
    s_mov_b32 s62, 0
    s_mov_b64 exec, 1
    s_waitcnt vmcnt(0)
    buffer_store_dwordx2 v[16:17], v11, s[36:39], s91 offen
    s_mov_b64 exec, -1
L_join0:
    s_mov_b64 exec, 1
    ds_add_u32 v14, v15 offset:4
    s_mov_b64 exec, -1
    ds_read_b64_tr_b16 v[32:33], v26 offset:6144
    ds_read_b64_tr_b16 v[34:35], v26 offset:6656
    ds_read_b64_tr_b16 v[36:37], v27 offset:6144
    ds_read_b64_tr_b16 v[38:39], v27 offset:6656
    ds_read_b64_tr_b16 v[40:41], v26 offset:10240
    ds_read_b64_tr_b16 v[42:43], v26 offset:10752
    ds_read_b64_tr_b16 v[44:45], v27 offset:10240
    ds_read_b64_tr_b16 v[46:47], v27 offset:10752
L_cntA:
    ds_read_b32 v5, v14 offset:4
    s_waitcnt lgkmcnt(0)
    v_readfirstlane_b32 s52, v5
    s_cmp_lt_u32 s52, 4
    s_cbranch_scc1 L_cntA
    buffer_load_dwordx4 v[128:131], v12, s[36:39], s20 offen offset:0 sc1
    buffer_load_dwordx4 v[132:135], v12, s[36:39], s20 offen offset:1024 sc1
    buffer_load_dwordx2 v[18:19], v13, s[36:39], s91 offen sc1
    s_waitcnt vmcnt(2) lgkmcnt(6)
    v_mfma_f32_32x32x16_bf16 v[64:79], v[32:35], v[128:131], 0
    ds_read_b64_tr_b16 v[48:49], v26 offset:8192
    ds_read_b64_tr_b16 v[50:51], v26 offset:8704
    s_waitcnt vmcnt(0)
    v_cmp_eq_u64 s[28:29], s[58:59], v[18:19]
    s_bfe_u32 s52, s28, 262152
    s_cmp_eq_u32 s52, 15
    s_cbranch_scc0 L_spin1
L_back1:
    buffer_load_dwordx4 v[136:139], v12, s[36:39], s21 offen offset:0 sc1
    buffer_load_dwordx4 v[140:143], v12, s[36:39], s21 offen offset:1024 sc1
    s_waitcnt lgkmcnt(6)
    v_mfma_f32_32x32x16_bf16 v[80:95], v[36:39], v[128:131], 0
    ds_read_b64_tr_b16 v[52:53], v27 offset:8192
    ds_read_b64_tr_b16 v[54:55], v27 offset:8704
    s_bfe_u32 s52, s28, 262160
    s_cmp_eq_u32 s52, 15
    s_cbranch_scc0 L_spin2
L_back2:
    buffer_load_dwordx4 v[144:147], v12, s[36:39], s22 offen offset:0 sc1
    s_waitcnt lgkmcnt(6)
    v_mfma_f32_32x32x16_bf16 v[96:111], v[40:43], v[128:131], 0
    ds_read_b64_tr_b16 v[56:57], v26 offset:12288
    ds_read_b64_tr_b16 v[58:59], v26 offset:12800
    s_waitcnt lgkmcnt(6)
    v_mfma_f32_32x32x16_bf16 v[112:127], v[44:47], v[128:131], 0
    ds_read_b64_tr_b16 v[60:61], v27 offset:12288
    ds_read_b64_tr_b16 v[62:63], v27 offset:12800
    s_waitcnt vmcnt(3) lgkmcnt(6)
    v_mfma_f32_32x32x16_bf16 v[64:79], v[48:51], v[132:135], v[64:79]
    ds_read_b64_tr_b16 v[32:33], v26 offset:14336
    ds_read_b64_tr_b16 v[34:35], v26 offset:14848
    buffer_load_dwordx4 v[148:151], v12, s[36:39], s22 offen offset:1024 sc1
    s_waitcnt lgkmcnt(6)
    v_mfma_f32_32x32x16_bf16 v[80:95], v[52:55], v[132:135], v[80:95]
    ds_read_b64_tr_b16 v[36:37], v27 offset:14336
    ds_read_b64_tr_b16 v[38:39], v27 offset:14848
    s_waitcnt lgkmcnt(6)
    v_mfma_f32_32x32x16_bf16 v[96:111], v[56:59], v[132:135], v[96:111]
    ds_read_b64_tr_b16 v[40:41], v26 offset:18432
    ds_read_b64_tr_b16 v[42:43], v26 offset:18944
    s_waitcnt lgkmcnt(6)
    v_mfma_f32_32x32x16_bf16 v[112:127], v[60:63], v[132:135], v[112:127]
    ds_read_b64_tr_b16 v[44:45], v27 offset:18432
    ds_read_b64_tr_b16 v[46:47], v27 offset:18944
    s_waitcnt vmcnt(3) lgkmcnt(6)
    v_mfma_f32_32x32x16_bf16 v[64:79], v[32:35], v[136:139], v[64:79]
    ds_read_b64_tr_b16 v[48:49], v26 offset:16384
    ds_read_b64_tr_b16 v[50:51], v26 offset:16896
    s_bfe_u32 s52, s28, 262168
    s_cmp_eq_u32 s52, 15
    s_cbranch_scc0 L_spin3
L_back3:
    buffer_load_dwordx4 v[152:155], v12, s[36:39], s23 offen offset:0 sc1
    s_waitcnt lgkmcnt(6)
    v_mfma_f32_32x32x16_bf16 v[80:95], v[36:39], v[136:139], v[80:95]
    ds_read_b64_tr_b16 v[52:53], v27 offset:16384
    ds_read_b64_tr_b16 v[54:55], v27 offset:16896
    s_waitcnt lgkmcnt(6)
    v_mfma_f32_32x32x16_bf16 v[96:111], v[40:43], v[136:139], v[96:111]
    ds_read_b64_tr_b16 v[56:57], v26 offset:20480
    ds_read_b64_tr_b16 v[58:59], v26 offset:20992
    s_waitcnt lgkmcnt(6)
    v_mfma_f32_32x32x16_bf16 v[112:127], v[44:47], v[136:139], v[112:127]
    ds_read_b64_tr_b16 v[60:61], v27 offset:20480
    ds_read_b64_tr_b16 v[62:63], v27 offset:20992
    s_waitcnt vmcnt(3) lgkmcnt(6)
L_cnt:
    ds_read_b32 v5, v14
    s_waitcnt lgkmcnt(0)
    v_readfirstlane_b32 s52, v5
    s_cmp_lt_u32 s52, 4
    s_cbranch_scc1 L_cnt
    v_mfma_f32_32x32x16_bf16 v[64:79], v[48:51], v[140:143], v[64:79]
    ds_read_b64_tr_b16 v[32:33], v22 offset:0
    ds_read_b64_tr_b16 v[34:35], v22 offset:512
    buffer_load_dwordx4 v[156:159], v12, s[36:39], s23 offen offset:1024 sc1
    s_waitcnt lgkmcnt(6)
    v_mfma_f32_32x32x16_bf16 v[80:95], v[52:55], v[140:143], v[80:95]
    ds_read_b64_tr_b16 v[36:37], v23 offset:0
    ds_read_b64_tr_b16 v[38:39], v23 offset:512
    s_waitcnt lgkmcnt(6)
    v_mfma_f32_32x32x16_bf16 v[96:111], v[56:59], v[140:143], v[96:111]
    ds_read_b64_tr_b16 v[40:41], v22 offset:4096
    ds_read_b64_tr_b16 v[42:43], v22 offset:4608
    s_waitcnt lgkmcnt(6)
    v_mfma_f32_32x32x16_bf16 v[112:127], v[60:63], v[140:143], v[112:127]
    ds_read_b64_tr_b16 v[44:45], v23 offset:4096
    ds_read_b64_tr_b16 v[46:47], v23 offset:4608
    s_waitcnt vmcnt(3) lgkmcnt(6)
    v_mfma_f32_32x32x16_bf16 v[64:79], v[32:35], v[144:147], v[64:79]
    ds_read_b64_tr_b16 v[48:49], v22 offset:2048
    ds_read_b64_tr_b16 v[50:51], v22 offset:2560
    s_bfe_u32 s52, s29, 262144
    s_cmp_eq_u32 s52, 15
    s_cbranch_scc0 L_spin4
L_back4:
    buffer_load_dwordx4 v[160:163], v12, s[36:39], s24 offen offset:0 sc1
    s_waitcnt lgkmcnt(6)
    v_mfma_f32_32x32x16_bf16 v[80:95], v[36:39], v[144:147], v[80:95]
    ds_read_b64_tr_b16 v[52:53], v23 offset:2048
    ds_read_b64_tr_b16 v[54:55], v23 offset:2560
    s_waitcnt lgkmcnt(6)
    v_mfma_f32_32x32x16_bf16 v[96:111], v[40:43], v[144:147], v[96:111]
    ds_read_b64_tr_b16 v[56:57], v22 offset:6144
    ds_read_b64_tr_b16 v[58:59], v22 offset:6656
    s_waitcnt lgkmcnt(6)
    v_mfma_f32_32x32x16_bf16 v[112:127], v[44:47], v[144:147], v[112:127]
    ds_read_b64_tr_b16 v[60:61], v23 offset:6144
    ds_read_b64_tr_b16 v[62:63], v23 offset:6656
    s_waitcnt vmcnt(3) lgkmcnt(6)
    v_mfma_f32_32x32x16_bf16 v[64:79], v[48:51], v[148:151], v[64:79]
    ds_read_b64_tr_b16 v[32:33], v22 offset:8192
    ds_read_b64_tr_b16 v[34:35], v22 offset:8704
    buffer_load_dwordx4 v[164:167], v12, s[36:39], s24 offen offset:1024 sc1
    s_waitcnt lgkmcnt(6)
    v_mfma_f32_32x32x16_bf16 v[80:95], v[52:55], v[148:151], v[80:95]
    ds_read_b64_tr_b16 v[36:37], v23 offset:8192
    ds_read_b64_tr_b16 v[38:39], v23 offset:8704
    s_waitcnt lgkmcnt(6)
    v_mfma_f32_32x32x16_bf16 v[96:111], v[56:59], v[148:151], v[96:111]
    ds_read_b64_tr_b16 v[40:41], v22 offset:12288
    ds_read_b64_tr_b16 v[42:43], v22 offset:12800
    s_waitcnt lgkmcnt(6)
    v_mfma_f32_32x32x16_bf16 v[112:127], v[60:63], v[148:151], v[112:127]
    ds_read_b64_tr_b16 v[44:45], v23 offset:12288
    ds_read_b64_tr_b16 v[46:47], v23 offset:12800
    s_waitcnt vmcnt(3) lgkmcnt(6)
    v_mfma_f32_32x32x16_bf16 v[64:79], v[32:35], v[152:155], v[64:79]
    ds_read_b64_tr_b16 v[48:49], v22 offset:10240
    ds_read_b64_tr_b16 v[50:51], v22 offset:10752
    s_bfe_u32 s52, s29, 262152
    s_cmp_eq_u32 s52, 15
    s_cbranch_scc0 L_spin5
L_back5:
    buffer_load_dwordx4 v[168:171], v12, s[36:39], s25 offen offset:0 sc1
    s_waitcnt lgkmcnt(6)
    v_mfma_f32_32x32x16_bf16 v[80:95], v[36:39], v[152:155], v[80:95]
    ds_read_b64_tr_b16 v[52:53], v23 offset:10240
    ds_read_b64_tr_b16 v[54:55], v23 offset:10752
    s_waitcnt lgkmcnt(6)
    v_mfma_f32_32x32x16_bf16 v[96:111], v[40:43], v[152:155], v[96:111]
    ds_read_b64_tr_b16 v[56:57], v22 offset:14336
    ds_read_b64_tr_b16 v[58:59], v22 offset:14848
    s_waitcnt lgkmcnt(6)
    v_mfma_f32_32x32x16_bf16 v[112:127], v[44:47], v[152:155], v[112:127]
    ds_read_b64_tr_b16 v[60:61], v23 offset:14336
    ds_read_b64_tr_b16 v[62:63], v23 offset:14848
    s_waitcnt vmcnt(3) lgkmcnt(6)
    v_mfma_f32_32x32x16_bf16 v[64:79], v[48:51], v[156:159], v[64:79]
    ds_read_b64_tr_b16 v[32:33], v22 offset:16384
    ds_read_b64_tr_b16 v[34:35], v22 offset:16896
    buffer_load_dwordx4 v[172:175], v12, s[36:39], s25 offen offset:1024 sc1
    s_waitcnt lgkmcnt(6)
    v_mfma_f32_32x32x16_bf16 v[80:95], v[52:55], v[156:159], v[80:95]
    ds_read_b64_tr_b16 v[36:37], v23 offset:16384
    ds_read_b64_tr_b16 v[38:39], v23 offset:16896
    s_waitcnt lgkmcnt(6)
    v_mfma_f32_32x32x16_bf16 v[96:111], v[56:59], v[156:159], v[96:111]
    ds_read_b64_tr_b16 v[40:41], v22 offset:20480
    ds_read_b64_tr_b16 v[42:43], v22 offset:20992
    s_waitcnt lgkmcnt(6)
    v_mfma_f32_32x32x16_bf16 v[112:127], v[60:63], v[156:159], v[112:127]
    ds_read_b64_tr_b16 v[44:45], v23 offset:20480
    ds_read_b64_tr_b16 v[46:47], v23 offset:20992
    s_waitcnt vmcnt(3) lgkmcnt(6)
    v_mfma_f32_32x32x16_bf16 v[64:79], v[32:35], v[160:163], v[64:79]
    ds_read_b64_tr_b16 v[48:49], v22 offset:18432
    ds_read_b64_tr_b16 v[50:51], v22 offset:18944
    s_bfe_u32 s52, s29, 262160
    s_cmp_eq_u32 s52, 15
    s_cbranch_scc0 L_spin6
L_back6:
    buffer_load_dwordx4 v[176:179], v12, s[36:39], s26 offen offset:0 sc1
    s_waitcnt lgkmcnt(6)
    v_mfma_f32_32x32x16_bf16 v[80:95], v[36:39], v[160:163], v[80:95]
    ds_read_b64_tr_b16 v[52:53], v23 offset:18432
    ds_read_b64_tr_b16 v[54:55], v23 offset:18944
    s_waitcnt lgkmcnt(6)
    v_mfma_f32_32x32x16_bf16 v[96:111], v[40:43], v[160:163], v[96:111]
    ds_read_b64_tr_b16 v[56:57], v22 offset:22528
    ds_read_b64_tr_b16 v[58:59], v22 offset:23040
    s_waitcnt lgkmcnt(6)
    v_mfma_f32_32x32x16_bf16 v[112:127], v[44:47], v[160:163], v[112:127]
    ds_read_b64_tr_b16 v[60:61], v23 offset:22528
    ds_read_b64_tr_b16 v[62:63], v23 offset:23040
    s_waitcnt vmcnt(3) lgkmcnt(6)
    v_mfma_f32_32x32x16_bf16 v[64:79], v[48:51], v[164:167], v[64:79]
    ds_read_b64_tr_b16 v[32:33], v22 offset:24576
    ds_read_b64_tr_b16 v[34:35], v22 offset:25088
    buffer_load_dwordx4 v[180:183], v12, s[36:39], s26 offen offset:1024 sc1
    s_waitcnt lgkmcnt(6)
    v_mfma_f32_32x32x16_bf16 v[80:95], v[52:55], v[164:167], v[80:95]
    ds_read_b64_tr_b16 v[36:37], v23 offset:24576
    ds_read_b64_tr_b16 v[38:39], v23 offset:25088
    s_waitcnt lgkmcnt(6)
    v_mfma_f32_32x32x16_bf16 v[96:111], v[56:59], v[164:167], v[96:111]
    ds_read_b64_tr_b16 v[40:41], v22 offset:28672
    ds_read_b64_tr_b16 v[42:43], v22 offset:29184
    s_waitcnt lgkmcnt(6)
    v_mfma_f32_32x32x16_bf16 v[112:127], v[60:63], v[164:167], v[112:127]
    ds_read_b64_tr_b16 v[44:45], v23 offset:28672
    ds_read_b64_tr_b16 v[46:47], v23 offset:29184
    s_waitcnt vmcnt(3) lgkmcnt(6)
    v_mfma_f32_32x32x16_bf16 v[64:79], v[32:35], v[168:171], v[64:79]
    ds_read_b64_tr_b16 v[48:49], v22 offset:26624
    ds_read_b64_tr_b16 v[50:51], v22 offset:27136
    s_bfe_u32 s52, s29, 262168
    s_cmp_eq_u32 s52, 15
    s_cbranch_scc0 L_spin7
L_back7:
    buffer_load_dwordx4 v[184:187], v12, s[36:39], s27 offen offset:0 sc1
    s_waitcnt lgkmcnt(6)
    v_mfma_f32_32x32x16_bf16 v[80:95], v[36:39], v[168:171], v[80:95]
    ds_read_b64_tr_b16 v[52:53], v23 offset:26624
    ds_read_b64_tr_b16 v[54:55], v23 offset:27136
    s_waitcnt lgkmcnt(6)
    v_mfma_f32_32x32x16_bf16 v[96:111], v[40:43], v[168:171], v[96:111]
    ds_read_b64_tr_b16 v[56:57], v22 offset:30720
    ds_read_b64_tr_b16 v[58:59], v22 offset:31232
    s_waitcnt lgkmcnt(6)
    v_mfma_f32_32x32x16_bf16 v[112:127], v[44:47], v[168:171], v[112:127]
    ds_read_b64_tr_b16 v[60:61], v23 offset:30720
    ds_read_b64_tr_b16 v[62:63], v23 offset:31232
    s_waitcnt vmcnt(3) lgkmcnt(6)
    v_mfma_f32_32x32x16_bf16 v[64:79], v[48:51], v[172:175], v[64:79]
    ds_read_b64_tr_b16 v[32:33], v22 offset:32768
    ds_read_b64_tr_b16 v[34:35], v22 offset:33280
    buffer_load_dwordx4 v[188:191], v12, s[36:39], s27 offen offset:1024 sc1
    s_waitcnt lgkmcnt(6)
    v_mfma_f32_32x32x16_bf16 v[80:95], v[52:55], v[172:175], v[80:95]
    ds_read_b64_tr_b16 v[36:37], v23 offset:32768
    ds_read_b64_tr_b16 v[38:39], v23 offset:33280
    s_waitcnt lgkmcnt(6)
    v_mfma_f32_32x32x16_bf16 v[96:111], v[56:59], v[172:175], v[96:111]
    ds_read_b64_tr_b16 v[40:41], v22 offset:36864
    ds_read_b64_tr_b16 v[42:43], v22 offset:37376
    s_waitcnt lgkmcnt(6)
    v_mfma_f32_32x32x16_bf16 v[112:127], v[60:63], v[172:175], v[112:127]
    ds_read_b64_tr_b16 v[44:45], v23 offset:36864
    ds_read_b64_tr_b16 v[46:47], v23 offset:37376
    s_waitcnt vmcnt(3) lgkmcnt(6)
    v_mfma_f32_32x32x16_bf16 v[64:79], v[32:35], v[176:179], v[64:79]
    ds_read_b64_tr_b16 v[48:49], v22 offset:34816
    ds_read_b64_tr_b16 v[50:51], v22 offset:35328
    s_bfe_u32 s52, s28, 262148
    s_cmp_eq_u32 s52, 15
    s_cbranch_scc0 L_spin8
L_back8:
    buffer_load_dwordx4 v[192:195], v12, s[36:39], s20 offen offset:2048 sc1
    buffer_load_dwordx4 v[196:199], v12, s[36:39], s20 offen offset:3072 sc1
    v_and_b32 v5, 31, v1
    v_lshrrev_b32 v6, 5, v1
    s_waitcnt lgkmcnt(6)
    v_mfma_f32_32x32x16_bf16 v[80:95], v[36:39], v[176:179], v[80:95]
    ds_read_b64_tr_b16 v[52:53], v23 offset:34816
    ds_read_b64_tr_b16 v[54:55], v23 offset:35328
    s_bfe_u32 s52, s28, 262156
    s_cmp_eq_u32 s52, 15
    s_cbranch_scc0 L_spin9
L_back9:
    buffer_load_dwordx4 v[200:203], v12, s[36:39], s21 offen offset:2048 sc1
    buffer_load_dwordx4 v[204:207], v12, s[36:39], s21 offen offset:3072 sc1
    v_and_b32 v7, 7, v5
    v_xor_b32 v7, v7, v6
    s_waitcnt lgkmcnt(6)
    v_mfma_f32_32x32x16_bf16 v[96:111], v[40:43], v[176:179], v[96:111]
    ds_read_b64_tr_b16 v[56:57], v22 offset:38912
    ds_read_b64_tr_b16 v[58:59], v22 offset:39424
    s_bfe_u32 s52, s28, 262164
    s_cmp_eq_u32 s52, 15
    s_cbranch_scc0 L_spin10
L_back10:
    buffer_load_dwordx4 v[208:211], v12, s[36:39], s22 offen offset:2048 sc1
    v_lshlrev_b32 v7, 4, v7
    v_lshl_add_u32 v7, v5, 7, v7
    s_waitcnt lgkmcnt(6)
    v_mfma_f32_32x32x16_bf16 v[112:127], v[44:47], v[176:179], v[112:127]
    ds_read_b64_tr_b16 v[60:61], v23 offset:38912
    ds_read_b64_tr_b16 v[62:63], v23 offset:39424
    s_lshl_b32 s53, s44, 13
    v_add_u32 v7, s53, v7
    s_waitcnt vmcnt(7) lgkmcnt(6)
    v_mfma_f32_32x32x16_bf16 v[64:79], v[48:51], v[180:183], v[64:79]
    ds_read_b64_tr_b16 v[32:33], v22 offset:40960
    ds_read_b64_tr_b16 v[34:35], v22 offset:41472
    buffer_load_dwordx4 v[212:215], v12, s[36:39], s22 offen offset:3072 sc1
    v_xor_b32 v8, 32, v7
    v_xor_b32 v9, 64, v7
    s_waitcnt lgkmcnt(6)
    v_mfma_f32_32x32x16_bf16 v[80:95], v[52:55], v[180:183], v[80:95]
    ds_read_b64_tr_b16 v[36:37], v23 offset:40960
    ds_read_b64_tr_b16 v[38:39], v23 offset:41472
    v_xor_b32 v10, 96, v7
    v_lshrrev_b32 v5, 3, v1
    s_waitcnt lgkmcnt(6)
    v_mfma_f32_32x32x16_bf16 v[96:111], v[56:59], v[180:183], v[96:111]
    ds_read_b64_tr_b16 v[40:41], v22 offset:45056
    ds_read_b64_tr_b16 v[42:43], v22 offset:45568
    v_and_b32 v6, 7, v1
    v_xor_b32 v11, v5, v6
    s_waitcnt lgkmcnt(6)
    v_mfma_f32_32x32x16_bf16 v[112:127], v[60:63], v[180:183], v[112:127]
    ds_read_b64_tr_b16 v[44:45], v23 offset:45056
    ds_read_b64_tr_b16 v[46:47], v23 offset:45568
    v_lshlrev_b32 v11, 4, v11
    v_lshl_add_u32 v11, v5, 7, v11
    s_waitcnt vmcnt(7) lgkmcnt(6)
    v_mfma_f32_32x32x16_bf16 v[64:79], v[32:35], v[184:187], v[64:79]
    ds_read_b64_tr_b16 v[48:49], v22 offset:43008
    ds_read_b64_tr_b16 v[50:51], v22 offset:43520
    s_bfe_u32 s52, s28, 262172
    s_cmp_eq_u32 s52, 15
    s_cbranch_scc0 L_spin11
L_back11:
    buffer_load_dwordx4 v[216:219], v12, s[36:39], s23 offen offset:2048 sc1
    v_add_u32 v11, s53, v11
    v_lshlrev_b32 v6, 4, v6
    s_waitcnt lgkmcnt(6)
    v_mfma_f32_32x32x16_bf16 v[80:95], v[36:39], v[184:187], v[80:95]
    ds_read_b64_tr_b16 v[52:53], v23 offset:43008
    ds_read_b64_tr_b16 v[54:55], v23 offset:43520
    v_lshl_add_u32 v6, v5, 10, v6
    s_and_b32 s53, s46, 3
    s_waitcnt lgkmcnt(6)
    v_mfma_f32_32x32x16_bf16 v[96:111], v[40:43], v[184:187], v[96:111]
    ds_read_b64_tr_b16 v[56:57], v22 offset:47104
    ds_read_b64_tr_b16 v[58:59], v22 offset:47616
    s_lshl_b32 s53, s53, 8
    s_add_u32 s90, s90, s53
    s_waitcnt lgkmcnt(6)
    v_mfma_f32_32x32x16_bf16 v[112:127], v[44:47], v[184:187], v[112:127]
    ds_read_b64_tr_b16 v[60:61], v23 offset:47104
    ds_read_b64_tr_b16 v[62:63], v23 offset:47616
    s_waitcnt vmcnt(7) lgkmcnt(6)
    s_barrier
    v_mfma_f32_32x32x16_bf16 v[64:79], v[48:51], v[188:191], v[64:79]
    ds_read_b64_tr_b16 v[32:33], v22 offset:50176
    ds_read_b64_tr_b16 v[34:35], v22 offset:50688
    buffer_load_dwordx4 v[220:223], v12, s[36:39], s23 offen offset:3072 sc1
    s_waitcnt lgkmcnt(6)
    v_mfma_f32_32x32x16_bf16 v[80:95], v[52:55], v[188:191], v[80:95]
    ds_read_b64_tr_b16 v[36:37], v23 offset:50176
    ds_read_b64_tr_b16 v[38:39], v23 offset:50688
    s_waitcnt lgkmcnt(6)
    v_mfma_f32_32x32x16_bf16 v[96:111], v[56:59], v[188:191], v[96:111]
    ds_read_b64_tr_b16 v[40:41], v22 offset:54272
    ds_read_b64_tr_b16 v[42:43], v22 offset:54784
    s_waitcnt lgkmcnt(6)
    v_mfma_f32_32x32x16_bf16 v[112:127], v[60:63], v[188:191], v[112:127]
    ds_read_b64_tr_b16 v[44:45], v23 offset:54272
    ds_read_b64_tr_b16 v[46:47], v23 offset:54784
    s_waitcnt vmcnt(7) lgkmcnt(6)
    v_mfma_f32_32x32x16_bf16 v[64:79], v[32:35], v[192:195], v[64:79]
    ds_read_b64_tr_b16 v[48:49], v22 offset:52224
    ds_read_b64_tr_b16 v[50:51], v22 offset:52736
    s_bfe_u32 s52, s29, 262148
    s_cmp_eq_u32 s52, 15
    s_cbranch_scc0 L_spin12
L_back12:
    buffer_load_dwordx4 v[224:227], v12, s[36:39], s24 offen offset:2048 sc1
    s_waitcnt lgkmcnt(6)
    v_mfma_f32_32x32x16_bf16 v[80:95], v[36:39], v[192:195], v[80:95]
    ds_read_b64_tr_b16 v[52:53], v23 offset:52224
    ds_read_b64_tr_b16 v[54:55], v23 offset:52736
    s_waitcnt lgkmcnt(6)
    v_mfma_f32_32x32x16_bf16 v[96:111], v[40:43], v[192:195], v[96:111]
    ds_read_b64_tr_b16 v[56:57], v22 offset:56320
    ds_read_b64_tr_b16 v[58:59], v22 offset:56832
    s_waitcnt lgkmcnt(6)
    v_mfma_f32_32x32x16_bf16 v[112:127], v[44:47], v[192:195], v[112:127]
    ds_read_b64_tr_b16 v[60:61], v23 offset:56320
    ds_read_b64_tr_b16 v[62:63], v23 offset:56832
    s_waitcnt vmcnt(7) lgkmcnt(6)
    v_mfma_f32_32x32x16_bf16 v[64:79], v[48:51], v[196:199], v[64:79]
    ds_read_b64_tr_b16 v[32:33], v22 offset:58368
    ds_read_b64_tr_b16 v[34:35], v22 offset:58880
    buffer_load_dwordx4 v[228:231], v12, s[36:39], s24 offen offset:3072 sc1
    s_waitcnt lgkmcnt(6)
    v_mfma_f32_32x32x16_bf16 v[80:95], v[52:55], v[196:199], v[80:95]
    ds_read_b64_tr_b16 v[36:37], v23 offset:58368
    ds_read_b64_tr_b16 v[38:39], v23 offset:58880
    s_waitcnt lgkmcnt(6)
    v_mfma_f32_32x32x16_bf16 v[96:111], v[56:59], v[196:199], v[96:111]
    ds_read_b64_tr_b16 v[40:41], v22 offset:62464
    ds_read_b64_tr_b16 v[42:43], v22 offset:62976
    s_waitcnt lgkmcnt(6)
    v_mfma_f32_32x32x16_bf16 v[112:127], v[60:63], v[196:199], v[112:127]
    ds_read_b64_tr_b16 v[44:45], v23 offset:62464
    ds_read_b64_tr_b16 v[46:47], v23 offset:62976
    s_waitcnt vmcnt(7) lgkmcnt(6)
    v_mfma_f32_32x32x16_bf16 v[64:79], v[32:35], v[200:203], v[64:79]
    ds_read_b64_tr_b16 v[48:49], v22 offset:60416
    ds_read_b64_tr_b16 v[50:51], v22 offset:60928
    s_bfe_u32 s52, s29, 262156
    s_cmp_eq_u32 s52, 15
    s_cbranch_scc0 L_spin13
L_back13:
    buffer_load_dwordx4 v[232:235], v12, s[36:39], s25 offen offset:2048 sc1
    s_waitcnt lgkmcnt(6)
    v_mfma_f32_32x32x16_bf16 v[80:95], v[36:39], v[200:203], v[80:95]
    ds_read_b64_tr_b16 v[52:53], v23 offset:60416
    ds_read_b64_tr_b16 v[54:55], v23 offset:60928
    s_waitcnt lgkmcnt(6)
    v_mfma_f32_32x32x16_bf16 v[96:111], v[40:43], v[200:203], v[96:111]
    ds_read_b64_tr_b16 v[56:57], v22 offset:64512
    ds_read_b64_tr_b16 v[58:59], v22 offset:65024
    s_waitcnt lgkmcnt(6)
    v_mfma_f32_32x32x16_bf16 v[112:127], v[44:47], v[200:203], v[112:127]
    ds_read_b64_tr_b16 v[60:61], v23 offset:64512
    ds_read_b64_tr_b16 v[62:63], v23 offset:65024
    s_waitcnt vmcnt(7) lgkmcnt(6)
    v_mfma_f32_32x32x16_bf16 v[64:79], v[48:51], v[204:207], v[64:79]
    ds_read_b64_tr_b16 v[32:33], v24 offset:1024
    ds_read_b64_tr_b16 v[34:35], v24 offset:1536
    buffer_load_dwordx4 v[236:239], v12, s[36:39], s25 offen offset:3072 sc1
    s_waitcnt lgkmcnt(6)
    v_mfma_f32_32x32x16_bf16 v[80:95], v[52:55], v[204:207], v[80:95]
    ds_read_b64_tr_b16 v[36:37], v25 offset:1024
    ds_read_b64_tr_b16 v[38:39], v25 offset:1536
    s_waitcnt lgkmcnt(6)
    v_mfma_f32_32x32x16_bf16 v[96:111], v[56:59], v[204:207], v[96:111]
    ds_read_b64_tr_b16 v[40:41], v24 offset:5120
    ds_read_b64_tr_b16 v[42:43], v24 offset:5632
    s_waitcnt lgkmcnt(6)
    v_mfma_f32_32x32x16_bf16 v[112:127], v[60:63], v[204:207], v[112:127]
    ds_read_b64_tr_b16 v[44:45], v25 offset:5120
    ds_read_b64_tr_b16 v[46:47], v25 offset:5632
    s_waitcnt vmcnt(7) lgkmcnt(6)
    v_mfma_f32_32x32x16_bf16 v[64:79], v[32:35], v[208:211], v[64:79]
    ds_read_b64_tr_b16 v[48:49], v24 offset:3072
    ds_read_b64_tr_b16 v[50:51], v24 offset:3584
    s_bfe_u32 s52, s29, 262164
    s_cmp_eq_u32 s52, 15
    s_cbranch_scc0 L_spin14
L_back14:
    buffer_load_dwordx4 v[240:243], v12, s[36:39], s26 offen offset:2048 sc1
    s_waitcnt lgkmcnt(6)
    v_mfma_f32_32x32x16_bf16 v[80:95], v[36:39], v[208:211], v[80:95]
    ds_read_b64_tr_b16 v[52:53], v25 offset:3072
    ds_read_b64_tr_b16 v[54:55], v25 offset:3584
    s_waitcnt lgkmcnt(6)
    v_mfma_f32_32x32x16_bf16 v[96:111], v[40:43], v[208:211], v[96:111]
    ds_read_b64_tr_b16 v[56:57], v24 offset:7168
    ds_read_b64_tr_b16 v[58:59], v24 offset:7680
    s_waitcnt lgkmcnt(6)
    v_mfma_f32_32x32x16_bf16 v[112:127], v[44:47], v[208:211], v[112:127]
    ds_read_b64_tr_b16 v[60:61], v25 offset:7168
    ds_read_b64_tr_b16 v[62:63], v25 offset:7680
    s_waitcnt vmcnt(7) lgkmcnt(6)
    v_mfma_f32_32x32x16_bf16 v[64:79], v[48:51], v[212:215], v[64:79]
    ds_read_b64_tr_b16 v[32:33], v24 offset:9216
    ds_read_b64_tr_b16 v[34:35], v24 offset:9728
    buffer_load_dwordx4 v[244:247], v12, s[36:39], s26 offen offset:3072 sc1
    s_waitcnt lgkmcnt(6)
    v_mfma_f32_32x32x16_bf16 v[80:95], v[52:55], v[212:215], v[80:95]
    ds_read_b64_tr_b16 v[36:37], v25 offset:9216
    ds_read_b64_tr_b16 v[38:39], v25 offset:9728
    s_waitcnt lgkmcnt(6)
    v_mfma_f32_32x32x16_bf16 v[96:111], v[56:59], v[212:215], v[96:111]
    ds_read_b64_tr_b16 v[40:41], v24 offset:13312
    ds_read_b64_tr_b16 v[42:43], v24 offset:13824
    s_waitcnt lgkmcnt(6)
    v_mfma_f32_32x32x16_bf16 v[112:127], v[60:63], v[212:215], v[112:127]
    ds_read_b64_tr_b16 v[44:45], v25 offset:13312
    ds_read_b64_tr_b16 v[46:47], v25 offset:13824
    s_waitcnt vmcnt(7) lgkmcnt(6)
    v_mfma_f32_32x32x16_bf16 v[64:79], v[32:35], v[216:219], v[64:79]
    ds_read_b64_tr_b16 v[48:49], v24 offset:11264
    ds_read_b64_tr_b16 v[50:51], v24 offset:11776
    s_bfe_u32 s52, s29, 262172
    s_cmp_eq_u32 s52, 15
    s_cbranch_scc0 L_spin15
L_back15:
    buffer_load_dwordx4 v[248:251], v12, s[36:39], s27 offen offset:2048 sc1
    s_waitcnt lgkmcnt(6)
    v_mfma_f32_32x32x16_bf16 v[80:95], v[36:39], v[216:219], v[80:95]
    ds_read_b64_tr_b16 v[52:53], v25 offset:11264
    ds_read_b64_tr_b16 v[54:55], v25 offset:11776
    s_waitcnt lgkmcnt(6)
    v_mfma_f32_32x32x16_bf16 v[96:111], v[40:43], v[216:219], v[96:111]
    ds_read_b64_tr_b16 v[56:57], v24 offset:15360
    ds_read_b64_tr_b16 v[58:59], v24 offset:15872
    s_waitcnt lgkmcnt(6)
    v_mfma_f32_32x32x16_bf16 v[112:127], v[44:47], v[216:219], v[112:127]
    ds_read_b64_tr_b16 v[60:61], v25 offset:15360
    ds_read_b64_tr_b16 v[62:63], v25 offset:15872
    s_waitcnt vmcnt(7) lgkmcnt(6)
    v_mfma_f32_32x32x16_bf16 v[64:79], v[48:51], v[220:223], v[64:79]
    ds_read_b64_tr_b16 v[32:33], v24 offset:17408
    ds_read_b64_tr_b16 v[34:35], v24 offset:17920
    buffer_load_dwordx4 v[252:255], v12, s[36:39], s27 offen offset:3072 sc1
    s_waitcnt lgkmcnt(6)
    v_mfma_f32_32x32x16_bf16 v[80:95], v[52:55], v[220:223], v[80:95]
    ds_read_b64_tr_b16 v[36:37], v25 offset:17408
    ds_read_b64_tr_b16 v[38:39], v25 offset:17920
    s_waitcnt lgkmcnt(6)
    v_mfma_f32_32x32x16_bf16 v[96:111], v[56:59], v[220:223], v[96:111]
    ds_read_b64_tr_b16 v[40:41], v24 offset:19456
    ds_read_b64_tr_b16 v[42:43], v24 offset:19968
    s_waitcnt lgkmcnt(6)
    v_mfma_f32_32x32x16_bf16 v[112:127], v[60:63], v[220:223], v[112:127]
    ds_read_b64_tr_b16 v[44:45], v25 offset:19456
    ds_read_b64_tr_b16 v[46:47], v25 offset:19968
    s_waitcnt vmcnt(7) lgkmcnt(6)
    v_mfma_f32_32x32x16_bf16 v[64:79], v[32:35], v[224:227], v[64:79]
    ds_read_b64_tr_b16 v[48:49], v24 offset:25600
    ds_read_b64_tr_b16 v[50:51], v24 offset:26112
    s_waitcnt lgkmcnt(6)
    v_mfma_f32_32x32x16_bf16 v[80:95], v[36:39], v[224:227], v[80:95]
    ds_read_b64_tr_b16 v[52:53], v25 offset:25600
    ds_read_b64_tr_b16 v[54:55], v25 offset:26112
    s_waitcnt vmcnt(6) lgkmcnt(6)
    v_mfma_f32_32x32x16_bf16 v[64:79], v[40:43], v[228:231], v[64:79]
    ds_read_b64_tr_b16 v[56:57], v24 offset:27648
    ds_read_b64_tr_b16 v[58:59], v24 offset:28160
    s_waitcnt lgkmcnt(6)
    v_mfma_f32_32x32x16_bf16 v[80:95], v[44:47], v[228:231], v[80:95]
    ds_read_b64_tr_b16 v[60:61], v25 offset:27648
    ds_read_b64_tr_b16 v[62:63], v25 offset:28160
    s_waitcnt vmcnt(5) lgkmcnt(6)
    s_barrier
    v_mfma_f32_32x32x16_bf16 v[64:79], v[48:51], v[232:235], v[64:79]
    ds_read_b64_tr_b16 v[32:33], v24 offset:34816
    ds_read_b64_tr_b16 v[34:35], v24 offset:35328
    s_waitcnt lgkmcnt(6)
    v_mfma_f32_32x32x16_bf16 v[80:95], v[52:55], v[232:235], v[80:95]
    ds_read_b64_tr_b16 v[36:37], v25 offset:34816
    ds_read_b64_tr_b16 v[38:39], v25 offset:35328
    s_waitcnt vmcnt(4) lgkmcnt(6)
    v_mfma_f32_32x32x16_bf16 v[64:79], v[56:59], v[236:239], v[64:79]
    ds_read_b64_tr_b16 v[40:41], v24 offset:36864
    ds_read_b64_tr_b16 v[42:43], v24 offset:37376
    s_waitcnt lgkmcnt(6)
    v_mfma_f32_32x32x16_bf16 v[80:95], v[60:63], v[236:239], v[80:95]
    ds_read_b64_tr_b16 v[44:45], v25 offset:36864
    ds_read_b64_tr_b16 v[46:47], v25 offset:37376
    s_waitcnt vmcnt(3) lgkmcnt(6)
    v_mfma_f32_32x32x16_bf16 v[64:79], v[32:35], v[240:243], v[64:79]
    ds_read_b64_tr_b16 v[48:49], v24 offset:43008
    ds_read_b64_tr_b16 v[50:51], v24 offset:43520
    s_waitcnt lgkmcnt(6)
    v_mfma_f32_32x32x16_bf16 v[80:95], v[36:39], v[240:243], v[80:95]
    ds_read_b64_tr_b16 v[52:53], v25 offset:43008
    ds_read_b64_tr_b16 v[54:55], v25 offset:43520
    s_waitcnt vmcnt(2) lgkmcnt(6)
    v_mfma_f32_32x32x16_bf16 v[64:79], v[40:43], v[244:247], v[64:79]
    ds_read_b64_tr_b16 v[56:57], v24 offset:45056
    ds_read_b64_tr_b16 v[58:59], v24 offset:45568
    s_waitcnt lgkmcnt(6)
    v_mfma_f32_32x32x16_bf16 v[80:95], v[44:47], v[244:247], v[80:95]
    ds_read_b64_tr_b16 v[60:61], v25 offset:45056
    ds_read_b64_tr_b16 v[62:63], v25 offset:45568
    s_waitcnt vmcnt(1) lgkmcnt(6)
    v_mfma_f32_32x32x16_bf16 v[64:79], v[48:51], v[248:251], v[64:79]
    ds_read_b64_tr_b16 v[32:33], v24 offset:21504
    ds_read_b64_tr_b16 v[34:35], v24 offset:22016
    s_waitcnt lgkmcnt(6)
    v_mfma_f32_32x32x16_bf16 v[80:95], v[52:55], v[248:251], v[80:95]
    ds_read_b64_tr_b16 v[36:37], v25 offset:21504
    ds_read_b64_tr_b16 v[38:39], v25 offset:22016
    s_waitcnt vmcnt(0) lgkmcnt(6)
    v_mfma_f32_32x32x16_bf16 v[64:79], v[56:59], v[252:255], v[64:79]
    ds_read_b64_tr_b16 v[40:41], v24 offset:23552
    ds_read_b64_tr_b16 v[42:43], v24 offset:24064
    s_waitcnt lgkmcnt(6)
    v_mfma_f32_32x32x16_bf16 v[80:95], v[60:63], v[252:255], v[80:95]
    ds_read_b64_tr_b16 v[44:45], v25 offset:23552
    ds_read_b64_tr_b16 v[46:47], v25 offset:24064
    s_waitcnt lgkmcnt(6)
    v_mfma_f32_32x32x16_bf16 v[96:111], v[32:35], v[224:227], v[96:111]
    ds_read_b64_tr_b16 v[48:49], v24 offset:29696
    ds_read_b64_tr_b16 v[50:51], v24 offset:30208
    s_waitcnt lgkmcnt(6)
    v_mfma_f32_32x32x16_bf16 v[112:127], v[36:39], v[224:227], v[112:127]
    ds_read_b64_tr_b16 v[52:53], v25 offset:29696
    ds_read_b64_tr_b16 v[54:55], v25 offset:30208
    v_cvt_pk_bf16_f32 v128, v64, v65
    v_cvt_pk_bf16_f32 v129, v66, v67
    v_cvt_pk_bf16_f32 v130, v68, v69
    v_cvt_pk_bf16_f32 v131, v70, v71
    v_cvt_pk_bf16_f32 v132, v72, v73
    s_waitcnt lgkmcnt(6)
    v_mfma_f32_32x32x16_bf16 v[96:111], v[40:43], v[228:231], v[96:111]
    ds_read_b64_tr_b16 v[56:57], v24 offset:31744
    ds_read_b64_tr_b16 v[58:59], v24 offset:32256
    v_cvt_pk_bf16_f32 v133, v74, v75
    v_cvt_pk_bf16_f32 v134, v76, v77
    v_cvt_pk_bf16_f32 v135, v78, v79
    v_cvt_pk_bf16_f32 v136, v80, v81
    v_cvt_pk_bf16_f32 v137, v82, v83
    s_waitcnt lgkmcnt(6)
    v_mfma_f32_32x32x16_bf16 v[112:127], v[44:47], v[228:231], v[112:127]
    ds_read_b64_tr_b16 v[60:61], v25 offset:31744
    ds_read_b64_tr_b16 v[62:63], v25 offset:32256
    v_cvt_pk_bf16_f32 v138, v84, v85
    v_cvt_pk_bf16_f32 v139, v86, v87
    v_cvt_pk_bf16_f32 v140, v88, v89
    v_cvt_pk_bf16_f32 v141, v90, v91
    v_cvt_pk_bf16_f32 v142, v92, v93
    s_waitcnt lgkmcnt(6)
    v_mfma_f32_32x32x16_bf16 v[96:111], v[48:51], v[232:235], v[96:111]
    ds_read_b64_tr_b16 v[32:33], v24 offset:38912
    ds_read_b64_tr_b16 v[34:35], v24 offset:39424
    v_cvt_pk_bf16_f32 v143, v94, v95
    v_permlane32_swap_b32 v128, v130
    v_permlane32_swap_b32 v129, v131
    v_permlane32_swap_b32 v132, v134
    v_permlane32_swap_b32 v133, v135
    s_waitcnt lgkmcnt(6)
    v_mfma_f32_32x32x16_bf16 v[112:127], v[52:55], v[232:235], v[112:127]
    ds_read_b64_tr_b16 v[36:37], v25 offset:38912
    ds_read_b64_tr_b16 v[38:39], v25 offset:39424
    v_permlane32_swap_b32 v136, v138
    v_permlane32_swap_b32 v137, v139
    v_permlane32_swap_b32 v140, v142
    v_permlane32_swap_b32 v141, v143
    ds_write_b128 v7, v[128:131] offset:0
    s_waitcnt lgkmcnt(6)
    v_mfma_f32_32x32x16_bf16 v[96:111], v[56:59], v[236:239], v[96:111]
    ds_read_b64_tr_b16 v[40:41], v24 offset:40960
    ds_read_b64_tr_b16 v[42:43], v24 offset:41472
    ds_write_b128 v8, v[132:135] offset:0
    ds_write_b128 v9, v[136:139] offset:0
    ds_write_b128 v10, v[140:143] offset:0
    s_waitcnt lgkmcnt(6)
    v_mfma_f32_32x32x16_bf16 v[112:127], v[60:63], v[236:239], v[112:127]
    ds_read_b64_tr_b16 v[44:45], v25 offset:40960
    ds_read_b64_tr_b16 v[46:47], v25 offset:41472
    s_waitcnt lgkmcnt(6)
    v_mfma_f32_32x32x16_bf16 v[96:111], v[32:35], v[240:243], v[96:111]
    ds_read_b64_tr_b16 v[48:49], v24 offset:47104
    ds_read_b64_tr_b16 v[50:51], v24 offset:47616
    s_waitcnt lgkmcnt(6)
    v_mfma_f32_32x32x16_bf16 v[112:127], v[36:39], v[240:243], v[112:127]
    ds_read_b64_tr_b16 v[52:53], v25 offset:47104
    ds_read_b64_tr_b16 v[54:55], v25 offset:47616
    s_waitcnt lgkmcnt(6)
    v_mfma_f32_32x32x16_bf16 v[96:111], v[40:43], v[244:247], v[96:111]
    ds_read_b64_tr_b16 v[56:57], v24 offset:49152
    ds_read_b64_tr_b16 v[58:59], v24 offset:49664
    s_waitcnt lgkmcnt(6)
    v_mfma_f32_32x32x16_bf16 v[112:127], v[44:47], v[244:247], v[112:127]
    ds_read_b64_tr_b16 v[60:61], v25 offset:49152
    ds_read_b64_tr_b16 v[62:63], v25 offset:49664
    s_waitcnt lgkmcnt(6)
    v_mfma_f32_32x32x16_bf16 v[96:111], v[48:51], v[248:251], v[96:111]
    s_waitcnt lgkmcnt(4)
    v_mfma_f32_32x32x16_bf16 v[112:127], v[52:55], v[248:251], v[112:127]
    s_waitcnt lgkmcnt(2)
    v_mfma_f32_32x32x16_bf16 v[96:111], v[56:59], v[252:255], v[96:111]
    s_waitcnt lgkmcnt(0)
    v_mfma_f32_32x32x16_bf16 v[112:127], v[60:63], v[252:255], v[112:127]
    s_waitcnt lgkmcnt(0)
    ds_read_b128 v[32:35], v11 offset:0
    ds_read_b128 v[36:39], v11 offset:1024
    ds_read_b128 v[40:43], v11 offset:2048
    ds_read_b128 v[44:47], v11 offset:3072
    s_nop 5
    v_cvt_pk_bf16_f32 v144, v96, v97
    v_cvt_pk_bf16_f32 v145, v98, v99
    v_cvt_pk_bf16_f32 v146, v100, v101
    v_cvt_pk_bf16_f32 v147, v102, v103
    v_cvt_pk_bf16_f32 v148, v104, v105
    v_cvt_pk_bf16_f32 v149, v106, v107
    v_cvt_pk_bf16_f32 v150, v108, v109
    v_cvt_pk_bf16_f32 v151, v110, v111
    v_cvt_pk_bf16_f32 v152, v112, v113
    v_cvt_pk_bf16_f32 v153, v114, v115
    v_cvt_pk_bf16_f32 v154, v116, v117
    v_cvt_pk_bf16_f32 v155, v118, v119
    v_cvt_pk_bf16_f32 v156, v120, v121
    v_cvt_pk_bf16_f32 v157, v122, v123
    v_cvt_pk_bf16_f32 v158, v124, v125
    v_cvt_pk_bf16_f32 v159, v126, v127
    s_waitcnt lgkmcnt(3)
    s_add_u32 s52, s90, 0
    buffer_store_dwordx4 v[32:35], v6, s[32:35], s52 offen nt
    s_waitcnt lgkmcnt(2)
    s_add_u32 s52, s90, 8192
    buffer_store_dwordx4 v[36:39], v6, s[32:35], s52 offen nt
    s_waitcnt lgkmcnt(1)
    s_add_u32 s52, s90, 16384
    buffer_store_dwordx4 v[40:43], v6, s[32:35], s52 offen nt
    s_waitcnt lgkmcnt(0)
    s_add_u32 s52, s90, 24576
    buffer_store_dwordx4 v[44:47], v6, s[32:35], s52 offen nt
    v_permlane32_swap_b32 v144, v146
    v_permlane32_swap_b32 v145, v147
    v_permlane32_swap_b32 v148, v150
    v_permlane32_swap_b32 v149, v151
    v_permlane32_swap_b32 v152, v154
    v_permlane32_swap_b32 v153, v155
    v_permlane32_swap_b32 v156, v158
    v_permlane32_swap_b32 v157, v159
    ds_write_b128 v7, v[144:147] offset:4096
    ds_write_b128 v8, v[148:151] offset:4096
    ds_write_b128 v9, v[152:155] offset:4096
    ds_write_b128 v10, v[156:159] offset:4096
    s_waitcnt lgkmcnt(0)
    ds_read_b128 v[48:51], v11 offset:4096
    ds_read_b128 v[52:55], v11 offset:5120
    ds_read_b128 v[56:59], v11 offset:6144
    ds_read_b128 v[60:63], v11 offset:7168
    s_waitcnt lgkmcnt(3)
    s_add_u32 s52, s90, 128
    buffer_store_dwordx4 v[48:51], v6, s[32:35], s52 offen nt
    s_waitcnt lgkmcnt(2)
    s_add_u32 s52, s90, 8320
    buffer_store_dwordx4 v[52:55], v6, s[32:35], s52 offen nt
    s_waitcnt lgkmcnt(1)
    s_add_u32 s52, s90, 16512
    buffer_store_dwordx4 v[56:59], v6, s[32:35], s52 offen nt
    s_waitcnt lgkmcnt(0)
    s_add_u32 s52, s90, 24704
    buffer_store_dwordx4 v[60:63], v6, s[32:35], s52 offen nt
L_end:
    s_endpgm
L_spin1:
    buffer_load_dwordx2 v[20:21], v13, s[36:39], s91 offen sc1
    s_add_u32 s62, s62, 1
    s_waitcnt vmcnt(0)
    v_cmp_eq_u64 s[28:29], s[58:59], v[20:21]
    s_cmp_ge_u32 s62, 0x40000
    s_cbranch_scc1 L_back1
    s_bfe_u32 s52, s28, 262152
    s_cmp_eq_u32 s52, 15
    s_cbranch_scc0 L_spin1
    s_branch L_back1
L_spin2:
    buffer_load_dwordx2 v[20:21], v13, s[36:39], s91 offen sc1
    s_add_u32 s62, s62, 1
    s_waitcnt vmcnt(0)
    v_cmp_eq_u64 s[28:29], s[58:59], v[20:21]
    s_cmp_ge_u32 s62, 0x40000
    s_cbranch_scc1 L_back2
    s_bfe_u32 s52, s28, 262160
    s_cmp_eq_u32 s52, 15
    s_cbranch_scc0 L_spin2
    s_branch L_back2
L_spin3:
    buffer_load_dwordx2 v[20:21], v13, s[36:39], s91 offen sc1
    s_add_u32 s62, s62, 1
    s_waitcnt vmcnt(0)
    v_cmp_eq_u64 s[28:29], s[58:59], v[20:21]
    s_cmp_ge_u32 s62, 0x40000
    s_cbranch_scc1 L_back3
    s_bfe_u32 s52, s28, 262168
    s_cmp_eq_u32 s52, 15
    s_cbranch_scc0 L_spin3
    s_branch L_back3
L_spin4:
    buffer_load_dwordx2 v[20:21], v13, s[36:39], s91 offen sc1
    s_add_u32 s62, s62, 1
    s_waitcnt vmcnt(0)
    v_cmp_eq_u64 s[28:29], s[58:59], v[20:21]
    s_cmp_ge_u32 s62, 0x40000
    s_cbranch_scc1 L_back4
    s_bfe_u32 s52, s29, 262144
    s_cmp_eq_u32 s52, 15
    s_cbranch_scc0 L_spin4
    s_branch L_back4
L_spin5:
    buffer_load_dwordx2 v[20:21], v13, s[36:39], s91 offen sc1
    s_add_u32 s62, s62, 1
    s_waitcnt vmcnt(0)
    v_cmp_eq_u64 s[28:29], s[58:59], v[20:21]
    s_cmp_ge_u32 s62, 0x40000
    s_cbranch_scc1 L_back5
    s_bfe_u32 s52, s29, 262152
    s_cmp_eq_u32 s52, 15
    s_cbranch_scc0 L_spin5
    s_branch L_back5
L_spin6:
    buffer_load_dwordx2 v[20:21], v13, s[36:39], s91 offen sc1
    s_add_u32 s62, s62, 1
    s_waitcnt vmcnt(0)
    v_cmp_eq_u64 s[28:29], s[58:59], v[20:21]
    s_cmp_ge_u32 s62, 0x40000
    s_cbranch_scc1 L_back6
    s_bfe_u32 s52, s29, 262160
    s_cmp_eq_u32 s52, 15
    s_cbranch_scc0 L_spin6
    s_branch L_back6
L_spin7:
    buffer_load_dwordx2 v[20:21], v13, s[36:39], s91 offen sc1
    s_add_u32 s62, s62, 1
    s_waitcnt vmcnt(0)
    v_cmp_eq_u64 s[28:29], s[58:59], v[20:21]
    s_cmp_ge_u32 s62, 0x40000
    s_cbranch_scc1 L_back7
    s_bfe_u32 s52, s29, 262168
    s_cmp_eq_u32 s52, 15
    s_cbranch_scc0 L_spin7
    s_branch L_back7
L_spin8:
    buffer_load_dwordx2 v[20:21], v13, s[36:39], s91 offen sc1
    s_add_u32 s62, s62, 1
    s_waitcnt vmcnt(0)
    v_cmp_eq_u64 s[28:29], s[58:59], v[20:21]
    s_cmp_ge_u32 s62, 0x40000
    s_cbranch_scc1 L_back8
    s_bfe_u32 s52, s28, 262148
    s_cmp_eq_u32 s52, 15
    s_cbranch_scc0 L_spin8
    s_branch L_back8
L_spin9:
    buffer_load_dwordx2 v[20:21], v13, s[36:39], s91 offen sc1
    s_add_u32 s62, s62, 1
    s_waitcnt vmcnt(0)
    v_cmp_eq_u64 s[28:29], s[58:59], v[20:21]
    s_cmp_ge_u32 s62, 0x40000
    s_cbranch_scc1 L_back9
    s_bfe_u32 s52, s28, 262156
    s_cmp_eq_u32 s52, 15
    s_cbranch_scc0 L_spin9
    s_branch L_back9
L_spin10:
    buffer_load_dwordx2 v[20:21], v13, s[36:39], s91 offen sc1
    s_add_u32 s62, s62, 1
    s_waitcnt vmcnt(0)
    v_cmp_eq_u64 s[28:29], s[58:59], v[20:21]
    s_cmp_ge_u32 s62, 0x40000
    s_cbranch_scc1 L_back10
    s_bfe_u32 s52, s28, 262164
    s_cmp_eq_u32 s52, 15
    s_cbranch_scc0 L_spin10
    s_branch L_back10
L_spin11:
    buffer_load_dwordx2 v[20:21], v13, s[36:39], s91 offen sc1
    s_add_u32 s62, s62, 1
    s_waitcnt vmcnt(0)
    v_cmp_eq_u64 s[28:29], s[58:59], v[20:21]
    s_cmp_ge_u32 s62, 0x40000
    s_cbranch_scc1 L_back11
    s_bfe_u32 s52, s28, 262172
    s_cmp_eq_u32 s52, 15
    s_cbranch_scc0 L_spin11
    s_branch L_back11
L_spin12:
    buffer_load_dwordx2 v[20:21], v13, s[36:39], s91 offen sc1
    s_add_u32 s62, s62, 1
    s_waitcnt vmcnt(0)
    v_cmp_eq_u64 s[28:29], s[58:59], v[20:21]
    s_cmp_ge_u32 s62, 0x40000
    s_cbranch_scc1 L_back12
    s_bfe_u32 s52, s29, 262148
    s_cmp_eq_u32 s52, 15
    s_cbranch_scc0 L_spin12
    s_branch L_back12
L_spin13:
    buffer_load_dwordx2 v[20:21], v13, s[36:39], s91 offen sc1
    s_add_u32 s62, s62, 1
    s_waitcnt vmcnt(0)
    v_cmp_eq_u64 s[28:29], s[58:59], v[20:21]
    s_cmp_ge_u32 s62, 0x40000
    s_cbranch_scc1 L_back13
    s_bfe_u32 s52, s29, 262156
    s_cmp_eq_u32 s52, 15
    s_cbranch_scc0 L_spin13
    s_branch L_back13
L_spin14:
    buffer_load_dwordx2 v[20:21], v13, s[36:39], s91 offen sc1
    s_add_u32 s62, s62, 1
    s_waitcnt vmcnt(0)
    v_cmp_eq_u64 s[28:29], s[58:59], v[20:21]
    s_cmp_ge_u32 s62, 0x40000
    s_cbranch_scc1 L_back14
    s_bfe_u32 s52, s29, 262164
    s_cmp_eq_u32 s52, 15
    s_cbranch_scc0 L_spin14
    s_branch L_back14
L_spin15:
    buffer_load_dwordx2 v[20:21], v13, s[36:39], s91 offen sc1
    s_add_u32 s62, s62, 1
    s_waitcnt vmcnt(0)
    v_cmp_eq_u64 s[28:29], s[58:59], v[20:21]
    s_cmp_ge_u32 s62, 0x40000
    s_cbranch_scc1 L_back15
    s_bfe_u32 s52, s29, 262172
    s_cmp_eq_u32 s52, 15
    s_cbranch_scc0 L_spin15
    s_branch L_back15
L_path1:
    s_waitcnt vmcnt(6)
    s_barrier
    ds_read_b64_tr_b16 v[176:177], v24 offset:0
    ds_read_b64_tr_b16 v[178:179], v24 offset:512
    ds_read_b64_tr_b16 v[180:181], v24 offset:8192
    ds_read_b64_tr_b16 v[182:183], v24 offset:8704
    ds_read_b128 v[104:107], v18 offset:16384
    ds_read_b128 v[108:111], v18 offset:18432
    ds_read_b128 v[112:115], v18 offset:20480
    ds_read_b128 v[116:119], v18 offset:22528
    ds_read_b128 v[120:123], v18 offset:24576
    ds_read_b128 v[124:127], v18 offset:26624
    ds_read_b128 v[128:131], v18 offset:28672
    ds_read_b128 v[132:135], v18 offset:30720
    s_xor_b32 s52, s92, 2
    s_add_u32 s52, s47, s52
    s_and_b32 s52, s52, 7
    s_lshl_b32 s53, s52, 17
    s_lshl_b32 s52, s52, 7
    s_add_u32 s54, s53, 1024
    s_cmp_eq_u32 s44, 7
    s_cbranch_scc0 L_noS_2
    s_mov_b32 m0, 149504
    s_nop 0
    buffer_load_dwordx4 v14, s[20:23], s52 offen lds
L_noS_2:
    s_add_u32 m0, s57, 100352
    s_nop 0
    buffer_load_dwordx4 v10, s[20:23], s52 offen lds
    s_add_u32 m0, s57, 101376
    s_nop 0
    buffer_load_dwordx4 v11, s[20:23], s52 offen lds
    s_add_u32 m0, s57, 102400
    s_nop 0
    buffer_load_dwordx4 v12, s[20:23], s52 offen lds
    s_add_u32 m0, s57, 103424
    s_nop 0
    buffer_load_dwordx4 v13, s[20:23], s52 offen lds
    s_add_u32 m0, s56, 100352
    s_nop 0
    buffer_load_dwordx4 v15, s[24:27], s53 offen lds
    s_add_u32 m0, s56, 108544
    s_nop 0
    buffer_load_dwordx4 v15, s[24:27], s54 offen lds
    s_waitcnt lgkmcnt(7)
    v_mfma_f32_16x16x32_bf16 v[32:35], v[104:107], v[176:179], 0
    ds_read_b64_tr_b16 v[184:185], v24 offset:4096
    v_mfma_f32_16x16x32_bf16 v[36:39], v[104:107], v[180:183], 0
    ds_read_b64_tr_b16 v[186:187], v24 offset:4608
    s_waitcnt lgkmcnt(8)
    v_mfma_f32_16x16x32_bf16 v[40:43], v[108:111], v[176:179], 0
    ds_read_b64_tr_b16 v[188:189], v24 offset:12288
    v_mfma_f32_16x16x32_bf16 v[44:47], v[108:111], v[180:183], 0
    ds_read_b64_tr_b16 v[190:191], v24 offset:12800
    s_waitcnt lgkmcnt(9)
    v_mfma_f32_16x16x32_bf16 v[48:51], v[112:115], v[176:179], 0
    ds_read_b128 v[140:143], v19 offset:16384
    v_mfma_f32_16x16x32_bf16 v[52:55], v[112:115], v[180:183], 0
    ds_read_b128 v[144:147], v19 offset:18432
    s_waitcnt lgkmcnt(10)
    v_mfma_f32_16x16x32_bf16 v[56:59], v[116:119], v[176:179], 0
    ds_read_b128 v[148:151], v19 offset:20480
    v_mfma_f32_16x16x32_bf16 v[60:63], v[116:119], v[180:183], 0
    ds_read_b128 v[152:155], v19 offset:22528
    s_waitcnt lgkmcnt(11)
    v_mfma_f32_16x16x32_bf16 v[64:67], v[120:123], v[176:179], 0
    ds_read_b128 v[156:159], v19 offset:24576
    v_mfma_f32_16x16x32_bf16 v[68:71], v[120:123], v[180:183], 0
    ds_read_b128 v[160:163], v19 offset:26624
    s_waitcnt lgkmcnt(12)
    v_mfma_f32_16x16x32_bf16 v[72:75], v[124:127], v[176:179], 0
    ds_read_b128 v[164:167], v19 offset:28672
    v_mfma_f32_16x16x32_bf16 v[76:79], v[124:127], v[180:183], 0
    ds_read_b128 v[168:171], v19 offset:30720
    s_waitcnt lgkmcnt(13)
    v_mfma_f32_16x16x32_bf16 v[80:83], v[128:131], v[176:179], 0
    v_mfma_f32_16x16x32_bf16 v[84:87], v[128:131], v[180:183], 0
    s_waitcnt lgkmcnt(12)
    v_mfma_f32_16x16x32_bf16 v[88:91], v[132:135], v[176:179], 0
    v_mfma_f32_16x16x32_bf16 v[92:95], v[132:135], v[180:183], 0
    s_waitcnt vmcnt(6) lgkmcnt(0)
    s_barrier
    v_mfma_f32_16x16x32_bf16 v[32:35], v[140:143], v[184:187], v[32:35]
    ds_read_b64_tr_b16 v[176:177], v25 offset:0
    v_mfma_f32_16x16x32_bf16 v[36:39], v[140:143], v[188:191], v[36:39]
    ds_read_b64_tr_b16 v[178:179], v25 offset:512
    v_mfma_f32_16x16x32_bf16 v[40:43], v[144:147], v[184:187], v[40:43]
    ds_read_b64_tr_b16 v[180:181], v25 offset:8192
    v_mfma_f32_16x16x32_bf16 v[44:47], v[144:147], v[188:191], v[44:47]
    ds_read_b64_tr_b16 v[182:183], v25 offset:8704
    v_mfma_f32_16x16x32_bf16 v[48:51], v[148:151], v[184:187], v[48:51]
    ds_read_b128 v[104:107], v20 offset:16384
    v_mfma_f32_16x16x32_bf16 v[52:55], v[148:151], v[188:191], v[52:55]
    ds_read_b128 v[108:111], v20 offset:18432
    v_mfma_f32_16x16x32_bf16 v[56:59], v[152:155], v[184:187], v[56:59]
    ds_read_b128 v[112:115], v20 offset:20480
    v_mfma_f32_16x16x32_bf16 v[60:63], v[152:155], v[188:191], v[60:63]
    ds_read_b128 v[116:119], v20 offset:22528
    v_mfma_f32_16x16x32_bf16 v[64:67], v[156:159], v[184:187], v[64:67]
    ds_read_b128 v[120:123], v20 offset:24576
    v_mfma_f32_16x16x32_bf16 v[68:71], v[156:159], v[188:191], v[68:71]
    ds_read_b128 v[124:127], v20 offset:26624
    v_mfma_f32_16x16x32_bf16 v[72:75], v[160:163], v[184:187], v[72:75]
    ds_read_b128 v[128:131], v20 offset:28672
    v_mfma_f32_16x16x32_bf16 v[76:79], v[160:163], v[188:191], v[76:79]
    ds_read_b128 v[132:135], v20 offset:30720
    v_mfma_f32_16x16x32_bf16 v[80:83], v[164:167], v[184:187], v[80:83]
    v_mfma_f32_16x16x32_bf16 v[84:87], v[164:167], v[188:191], v[84:87]
    v_mfma_f32_16x16x32_bf16 v[88:91], v[168:171], v[184:187], v[88:91]
    v_mfma_f32_16x16x32_bf16 v[92:95], v[168:171], v[188:191], v[92:95]
    s_xor_b32 s52, s92, 3
    s_add_u32 s52, s47, s52
    s_and_b32 s52, s52, 7
    s_lshl_b32 s53, s52, 17
    s_lshl_b32 s52, s52, 7
    s_add_u32 s54, s53, 1024
    s_cmp_eq_u32 s44, 7
    s_cbranch_scc0 L_noS_3
    s_mov_b32 m0, 49152
    s_nop 0
    buffer_load_dwordx4 v14, s[20:23], s52 offen lds
L_noS_3:
    s_add_u32 m0, s57, 0
    s_nop 0
    buffer_load_dwordx4 v10, s[20:23], s52 offen lds
    s_add_u32 m0, s57, 1024
    s_nop 0
    buffer_load_dwordx4 v11, s[20:23], s52 offen lds
    s_add_u32 m0, s57, 2048
    s_nop 0
    buffer_load_dwordx4 v12, s[20:23], s52 offen lds
    s_add_u32 m0, s57, 3072
    s_nop 0
    buffer_load_dwordx4 v13, s[20:23], s52 offen lds
    s_add_u32 m0, s56, 0
    s_nop 0
    buffer_load_dwordx4 v15, s[24:27], s53 offen lds
    s_add_u32 m0, s56, 8192
    s_nop 0
    buffer_load_dwordx4 v15, s[24:27], s54 offen lds
    s_waitcnt lgkmcnt(7)
    v_mfma_f32_16x16x32_bf16 v[32:35], v[104:107], v[176:179], v[32:35]
    ds_read_b128 v[224:227], v9 offset:0
    ds_read_b128 v[228:231], v9 offset:144
    v_mfma_f32_16x16x32_bf16 v[36:39], v[104:107], v[180:183], v[36:39]
    ds_read_b128 v[232:235], v9 offset:288
    ds_read_b128 v[236:239], v9 offset:432
    s_waitcnt lgkmcnt(10)
    v_mfma_f32_16x16x32_bf16 v[40:43], v[108:111], v[176:179], v[40:43]
    ds_read_b128 v[240:243], v9 offset:576
    ds_read_b128 v[244:247], v9 offset:720
    v_mfma_f32_16x16x32_bf16 v[44:47], v[108:111], v[180:183], v[44:47]
    ds_read_b128 v[248:251], v9 offset:864
    ds_read_b128 v[252:255], v9 offset:1008
    s_waitcnt lgkmcnt(13)
    v_mfma_f32_16x16x32_bf16 v[48:51], v[112:115], v[176:179], v[48:51]
    ds_read_b64_tr_b16 v[184:185], v25 offset:4096
    ds_read_b64_tr_b16 v[186:187], v25 offset:4608
    v_mfma_f32_16x16x32_bf16 v[52:55], v[112:115], v[180:183], v[52:55]
    ds_read_b64_tr_b16 v[188:189], v25 offset:12288
    s_waitcnt lgkmcnt(15)
    v_mfma_f32_16x16x32_bf16 v[56:59], v[116:119], v[176:179], v[56:59]
    ds_read_b64_tr_b16 v[190:191], v25 offset:12800
    v_mfma_f32_16x16x32_bf16 v[60:63], v[116:119], v[180:183], v[60:63]
    ds_read_b128 v[140:143], v21 offset:16384
    s_waitcnt lgkmcnt(15)
    v_mfma_f32_16x16x32_bf16 v[64:67], v[120:123], v[176:179], v[64:67]
    ds_read_b128 v[144:147], v21 offset:18432
    v_mfma_f32_16x16x32_bf16 v[68:71], v[120:123], v[180:183], v[68:71]
    ds_read_b128 v[148:151], v21 offset:20480
    s_waitcnt lgkmcnt(15)
    v_mfma_f32_16x16x32_bf16 v[72:75], v[124:127], v[176:179], v[72:75]
    ds_read_b128 v[152:155], v21 offset:22528
    v_mfma_f32_16x16x32_bf16 v[76:79], v[124:127], v[180:183], v[76:79]
    ds_read_b128 v[156:159], v21 offset:24576
    s_waitcnt lgkmcnt(15)
    v_mfma_f32_16x16x32_bf16 v[80:83], v[128:131], v[176:179], v[80:83]
    ds_read_b128 v[160:163], v21 offset:26624
    v_mfma_f32_16x16x32_bf16 v[84:87], v[128:131], v[180:183], v[84:87]
    ds_read_b128 v[164:167], v21 offset:28672
    s_waitcnt lgkmcnt(15)
    v_mfma_f32_16x16x32_bf16 v[88:91], v[132:135], v[176:179], v[88:91]
    ds_read_b128 v[168:171], v21 offset:30720
    v_mfma_f32_16x16x32_bf16 v[92:95], v[132:135], v[180:183], v[92:95]
    s_waitcnt vmcnt(6) lgkmcnt(0)
    s_barrier
    v_mfma_f32_16x16x32_bf16 v[32:35], v[140:143], v[184:187], v[32:35]
    ds_read_b64_tr_b16 v[176:177], v26 offset:0
    v_mfma_f32_16x16x32_bf16 v[36:39], v[140:143], v[188:191], v[36:39]
    ds_read_b64_tr_b16 v[178:179], v26 offset:512
    v_mfma_f32_16x16x32_bf16 v[40:43], v[144:147], v[184:187], v[40:43]
    ds_read_b64_tr_b16 v[180:181], v26 offset:8192
    v_mfma_f32_16x16x32_bf16 v[44:47], v[144:147], v[188:191], v[44:47]
    ds_read_b64_tr_b16 v[182:183], v26 offset:8704
    v_mfma_f32_16x16x32_bf16 v[48:51], v[148:151], v[184:187], v[48:51]
    ds_read_b128 v[104:107], v22 offset:16384
    v_mfma_f32_16x16x32_bf16 v[52:55], v[148:151], v[188:191], v[52:55]
    ds_read_b128 v[108:111], v22 offset:18432
    v_mfma_f32_16x16x32_bf16 v[56:59], v[152:155], v[184:187], v[56:59]
    ds_read_b128 v[112:115], v22 offset:20480
    v_mfma_f32_16x16x32_bf16 v[60:63], v[152:155], v[188:191], v[60:63]
    ds_read_b128 v[116:119], v22 offset:22528
    v_mfma_f32_16x16x32_bf16 v[64:67], v[156:159], v[184:187], v[64:67]
    ds_read_b128 v[120:123], v22 offset:24576
    v_mfma_f32_16x16x32_bf16 v[68:71], v[156:159], v[188:191], v[68:71]
    ds_read_b128 v[124:127], v22 offset:26624
    v_mfma_f32_16x16x32_bf16 v[72:75], v[160:163], v[184:187], v[72:75]
    ds_read_b128 v[128:131], v22 offset:28672
    v_mfma_f32_16x16x32_bf16 v[76:79], v[160:163], v[188:191], v[76:79]
    ds_read_b128 v[132:135], v22 offset:30720
    v_mfma_f32_16x16x32_bf16 v[80:83], v[164:167], v[184:187], v[80:83]
    v_perm_b32 v192, v228, v224, s60
    v_mfma_f32_16x16x32_bf16 v[84:87], v[164:167], v[188:191], v[84:87]
    v_perm_b32 v193, v236, v232, s60
    v_mfma_f32_16x16x32_bf16 v[88:91], v[168:171], v[184:187], v[88:91]
    v_perm_b32 v194, v244, v240, s60
    v_mfma_f32_16x16x32_bf16 v[92:95], v[168:171], v[188:191], v[92:95]
    v_perm_b32 v195, v252, v248, s60
    s_xor_b32 s52, s92, 4
    s_add_u32 s52, s47, s52
    s_and_b32 s52, s52, 7
    s_lshl_b32 s53, s52, 17
    s_lshl_b32 s52, s52, 7
    s_add_u32 s54, s53, 1024
    s_cmp_eq_u32 s44, 7
    s_cbranch_scc0 L_noS_4
    s_mov_b32 m0, 99328
    s_nop 0
    buffer_load_dwordx4 v14, s[20:23], s52 offen lds
L_noS_4:
    s_add_u32 m0, s57, 50176
    s_nop 0
    buffer_load_dwordx4 v10, s[20:23], s52 offen lds
    s_add_u32 m0, s57, 51200
    s_nop 0
    buffer_load_dwordx4 v11, s[20:23], s52 offen lds
    s_add_u32 m0, s57, 52224
    s_nop 0
    buffer_load_dwordx4 v12, s[20:23], s52 offen lds
    s_add_u32 m0, s57, 53248
    s_nop 0
    buffer_load_dwordx4 v13, s[20:23], s52 offen lds
    s_add_u32 m0, s56, 50176
    s_nop 0
    buffer_load_dwordx4 v15, s[24:27], s53 offen lds
    s_add_u32 m0, s56, 58368
    s_nop 0
    buffer_load_dwordx4 v15, s[24:27], s54 offen lds
    s_waitcnt lgkmcnt(7)
    v_mfma_f32_16x16x32_bf16 v[32:35], v[104:107], v[176:179], v[32:35]
    ds_read_b64_tr_b16 v[184:185], v26 offset:4096
    v_mfma_f32_16x16x32_bf16 v[36:39], v[104:107], v[180:183], v[36:39]
    ds_read_b64_tr_b16 v[186:187], v26 offset:4608
    s_waitcnt lgkmcnt(8)
    v_mfma_f32_16x16x32_bf16 v[40:43], v[108:111], v[176:179], v[40:43]
    ds_read_b64_tr_b16 v[188:189], v26 offset:12288
    v_mfma_f32_16x16x32_bf16 v[44:47], v[108:111], v[180:183], v[44:47]
    ds_read_b64_tr_b16 v[190:191], v26 offset:12800
    s_waitcnt lgkmcnt(9)
    v_mfma_f32_16x16x32_bf16 v[48:51], v[112:115], v[176:179], v[48:51]
    ds_read_b128 v[140:143], v23 offset:16384
    v_mfma_f32_16x16x32_bf16 v[52:55], v[112:115], v[180:183], v[52:55]
    ds_read_b128 v[144:147], v23 offset:18432
    s_waitcnt lgkmcnt(10)
    v_mfma_f32_16x16x32_bf16 v[56:59], v[116:119], v[176:179], v[56:59]
    ds_read_b128 v[148:151], v23 offset:20480
    v_mfma_f32_16x16x32_bf16 v[60:63], v[116:119], v[180:183], v[60:63]
    ds_read_b128 v[152:155], v23 offset:22528
    s_waitcnt lgkmcnt(11)
    v_mfma_f32_16x16x32_bf16 v[64:67], v[120:123], v[176:179], v[64:67]
    ds_read_b128 v[156:159], v23 offset:24576
    v_mfma_f32_16x16x32_bf16 v[68:71], v[120:123], v[180:183], v[68:71]
    ds_read_b128 v[160:163], v23 offset:26624
    s_waitcnt lgkmcnt(12)
    v_mfma_f32_16x16x32_bf16 v[72:75], v[124:127], v[176:179], v[72:75]
    ds_read_b128 v[164:167], v23 offset:28672
    v_mfma_f32_16x16x32_bf16 v[76:79], v[124:127], v[180:183], v[76:79]
    ds_read_b128 v[168:171], v23 offset:30720
    s_waitcnt lgkmcnt(13)
    v_mfma_f32_16x16x32_bf16 v[80:83], v[128:131], v[176:179], v[80:83]
    v_perm_b32 v196, v228, v224, s61
    v_mfma_f32_16x16x32_bf16 v[84:87], v[128:131], v[180:183], v[84:87]
    v_perm_b32 v197, v236, v232, s61
    s_waitcnt lgkmcnt(12)
    v_mfma_f32_16x16x32_bf16 v[88:91], v[132:135], v[176:179], v[88:91]
    v_perm_b32 v198, v244, v240, s61
    v_mfma_f32_16x16x32_bf16 v[92:95], v[132:135], v[180:183], v[92:95]
    v_perm_b32 v199, v252, v248, s61
    s_waitcnt vmcnt(6) lgkmcnt(0)
    s_barrier
    v_mfma_f32_16x16x32_bf16 v[32:35], v[140:143], v[184:187], v[32:35]
    ds_read_b64_tr_b16 v[176:177], v24 offset:0
    v_mfma_f32_16x16x32_bf16 v[36:39], v[140:143], v[188:191], v[36:39]
    ds_read_b64_tr_b16 v[178:179], v24 offset:512
    v_mfma_f32_16x16x32_bf16 v[40:43], v[144:147], v[184:187], v[40:43]
    ds_read_b64_tr_b16 v[180:181], v24 offset:8192
    v_mfma_f32_16x16x32_bf16 v[44:47], v[144:147], v[188:191], v[44:47]
    ds_read_b64_tr_b16 v[182:183], v24 offset:8704
    v_mfma_f32_16x16x32_bf16 v[48:51], v[148:151], v[184:187], v[48:51]
    ds_read_b128 v[104:107], v18 offset:16384
    v_mfma_f32_16x16x32_bf16 v[52:55], v[148:151], v[188:191], v[52:55]
    ds_read_b128 v[108:111], v18 offset:18432
    v_mfma_f32_16x16x32_bf16 v[56:59], v[152:155], v[184:187], v[56:59]
    ds_read_b128 v[112:115], v18 offset:20480
    v_mfma_f32_16x16x32_bf16 v[60:63], v[152:155], v[188:191], v[60:63]
    ds_read_b128 v[116:119], v18 offset:22528
    v_mfma_f32_16x16x32_bf16 v[64:67], v[156:159], v[184:187], v[64:67]
    ds_read_b128 v[120:123], v18 offset:24576
    v_mfma_f32_16x16x32_bf16 v[68:71], v[156:159], v[188:191], v[68:71]
    ds_read_b128 v[124:127], v18 offset:26624
    v_mfma_f32_16x16x32_bf16 v[72:75], v[160:163], v[184:187], v[72:75]
    ds_read_b128 v[128:131], v18 offset:28672
    v_mfma_f32_16x16x32_bf16 v[76:79], v[160:163], v[188:191], v[76:79]
    ds_read_b128 v[132:135], v18 offset:30720
    v_mfma_f32_16x16x32_bf16 v[80:83], v[164:167], v[184:187], v[80:83]
    v_perm_b32 v200, v229, v225, s60
    v_mfma_f32_16x16x32_bf16 v[84:87], v[164:167], v[188:191], v[84:87]
    v_perm_b32 v201, v237, v233, s60
    v_mfma_f32_16x16x32_bf16 v[88:91], v[168:171], v[184:187], v[88:91]
    v_perm_b32 v202, v245, v241, s60
    v_mfma_f32_16x16x32_bf16 v[92:95], v[168:171], v[188:191], v[92:95]
    v_perm_b32 v203, v253, v249, s60
    s_xor_b32 s52, s92, 5
    s_add_u32 s52, s47, s52
    s_and_b32 s52, s52, 7
    s_lshl_b32 s53, s52, 17
    s_lshl_b32 s52, s52, 7
    s_add_u32 s54, s53, 1024
    s_cmp_eq_u32 s44, 7
    s_cbranch_scc0 L_noS_5
    s_mov_b32 m0, 149504
    s_nop 0
    buffer_load_dwordx4 v14, s[20:23], s52 offen lds
L_noS_5:
    s_add_u32 m0, s57, 100352
    s_nop 0
    buffer_load_dwordx4 v10, s[20:23], s52 offen lds
    s_add_u32 m0, s57, 101376
    s_nop 0
    buffer_load_dwordx4 v11, s[20:23], s52 offen lds
    s_add_u32 m0, s57, 102400
    s_nop 0
    buffer_load_dwordx4 v12, s[20:23], s52 offen lds
    s_add_u32 m0, s57, 103424
    s_nop 0
    buffer_load_dwordx4 v13, s[20:23], s52 offen lds
    s_add_u32 m0, s56, 100352
    s_nop 0
    buffer_load_dwordx4 v15, s[24:27], s53 offen lds
    s_add_u32 m0, s56, 108544
    s_nop 0
    buffer_load_dwordx4 v15, s[24:27], s54 offen lds
    s_waitcnt lgkmcnt(7)
    v_mfma_f32_16x16x32_bf16 v[32:35], v[104:107], v[176:179], v[32:35]
    ds_read_b64_tr_b16 v[184:185], v24 offset:4096
    v_mfma_f32_16x16x32_bf16 v[36:39], v[104:107], v[180:183], v[36:39]
    ds_read_b64_tr_b16 v[186:187], v24 offset:4608
    s_waitcnt lgkmcnt(8)
    v_mfma_f32_16x16x32_bf16 v[40:43], v[108:111], v[176:179], v[40:43]
    ds_read_b64_tr_b16 v[188:189], v24 offset:12288
    v_mfma_f32_16x16x32_bf16 v[44:47], v[108:111], v[180:183], v[44:47]
    ds_read_b64_tr_b16 v[190:191], v24 offset:12800
    s_waitcnt lgkmcnt(9)
    v_mfma_f32_16x16x32_bf16 v[48:51], v[112:115], v[176:179], v[48:51]
    ds_read_b128 v[140:143], v19 offset:16384
    v_mfma_f32_16x16x32_bf16 v[52:55], v[112:115], v[180:183], v[52:55]
    ds_read_b128 v[144:147], v19 offset:18432
    s_waitcnt lgkmcnt(10)
    v_mfma_f32_16x16x32_bf16 v[56:59], v[116:119], v[176:179], v[56:59]
    ds_read_b128 v[148:151], v19 offset:20480
    v_mfma_f32_16x16x32_bf16 v[60:63], v[116:119], v[180:183], v[60:63]
    ds_read_b128 v[152:155], v19 offset:22528
    s_waitcnt lgkmcnt(11)
    v_mfma_f32_16x16x32_bf16 v[64:67], v[120:123], v[176:179], v[64:67]
    ds_read_b128 v[156:159], v19 offset:24576
    v_mfma_f32_16x16x32_bf16 v[68:71], v[120:123], v[180:183], v[68:71]
    ds_read_b128 v[160:163], v19 offset:26624
    s_waitcnt lgkmcnt(12)
    v_mfma_f32_16x16x32_bf16 v[72:75], v[124:127], v[176:179], v[72:75]
    ds_read_b128 v[164:167], v19 offset:28672
    v_mfma_f32_16x16x32_bf16 v[76:79], v[124:127], v[180:183], v[76:79]
    ds_read_b128 v[168:171], v19 offset:30720
    s_waitcnt lgkmcnt(13)
    v_mfma_f32_16x16x32_bf16 v[80:83], v[128:131], v[176:179], v[80:83]
    v_perm_b32 v204, v229, v225, s61
    v_mfma_f32_16x16x32_bf16 v[84:87], v[128:131], v[180:183], v[84:87]
    v_perm_b32 v205, v237, v233, s61
    s_waitcnt lgkmcnt(12)
    v_mfma_f32_16x16x32_bf16 v[88:91], v[132:135], v[176:179], v[88:91]
    v_perm_b32 v206, v245, v241, s61
    v_mfma_f32_16x16x32_bf16 v[92:95], v[132:135], v[180:183], v[92:95]
    v_perm_b32 v207, v253, v249, s61
    s_waitcnt vmcnt(6) lgkmcnt(0)
    s_barrier
    v_mfma_f32_16x16x32_bf16 v[32:35], v[140:143], v[184:187], v[32:35]
    ds_read_b64_tr_b16 v[176:177], v25 offset:0
    v_mfma_f32_16x16x32_bf16 v[36:39], v[140:143], v[188:191], v[36:39]
    ds_read_b64_tr_b16 v[178:179], v25 offset:512
    v_mfma_f32_16x16x32_bf16 v[40:43], v[144:147], v[184:187], v[40:43]
    ds_read_b64_tr_b16 v[180:181], v25 offset:8192
    v_mfma_f32_16x16x32_bf16 v[44:47], v[144:147], v[188:191], v[44:47]
    ds_read_b64_tr_b16 v[182:183], v25 offset:8704
    v_mfma_f32_16x16x32_bf16 v[48:51], v[148:151], v[184:187], v[48:51]
    ds_read_b128 v[104:107], v20 offset:16384
    v_mfma_f32_16x16x32_bf16 v[52:55], v[148:151], v[188:191], v[52:55]
    ds_read_b128 v[108:111], v20 offset:18432
    v_mfma_f32_16x16x32_bf16 v[56:59], v[152:155], v[184:187], v[56:59]
    ds_read_b128 v[112:115], v20 offset:20480
    v_mfma_f32_16x16x32_bf16 v[60:63], v[152:155], v[188:191], v[60:63]
    ds_read_b128 v[116:119], v20 offset:22528
    v_mfma_f32_16x16x32_bf16 v[64:67], v[156:159], v[184:187], v[64:67]
    ds_read_b128 v[120:123], v20 offset:24576
    v_mfma_f32_16x16x32_bf16 v[68:71], v[156:159], v[188:191], v[68:71]
    ds_read_b128 v[124:127], v20 offset:26624
    v_mfma_f32_16x16x32_bf16 v[72:75], v[160:163], v[184:187], v[72:75]
    ds_read_b128 v[128:131], v20 offset:28672
    v_mfma_f32_16x16x32_bf16 v[76:79], v[160:163], v[188:191], v[76:79]
    ds_read_b128 v[132:135], v20 offset:30720
    v_mfma_f32_16x16x32_bf16 v[80:83], v[164:167], v[184:187], v[80:83]
    v_perm_b32 v208, v230, v226, s60
    v_mfma_f32_16x16x32_bf16 v[84:87], v[164:167], v[188:191], v[84:87]
    v_perm_b32 v209, v238, v234, s60
    v_mfma_f32_16x16x32_bf16 v[88:91], v[168:171], v[184:187], v[88:91]
    v_perm_b32 v210, v246, v242, s60
    v_mfma_f32_16x16x32_bf16 v[92:95], v[168:171], v[188:191], v[92:95]
    v_perm_b32 v211, v254, v250, s60
    s_xor_b32 s52, s92, 6
    s_add_u32 s52, s47, s52
    s_and_b32 s52, s52, 7
    s_lshl_b32 s53, s52, 17
    s_lshl_b32 s52, s52, 7
    s_add_u32 s54, s53, 1024
    s_cmp_eq_u32 s44, 7
    s_cbranch_scc0 L_noS_6
    s_mov_b32 m0, 49152
    s_nop 0
    buffer_load_dwordx4 v14, s[20:23], s52 offen lds
L_noS_6:
    s_add_u32 m0, s57, 0
    s_nop 0
    buffer_load_dwordx4 v10, s[20:23], s52 offen lds
    s_add_u32 m0, s57, 1024
    s_nop 0
    buffer_load_dwordx4 v11, s[20:23], s52 offen lds
    s_add_u32 m0, s57, 2048
    s_nop 0
    buffer_load_dwordx4 v12, s[20:23], s52 offen lds
    s_add_u32 m0, s57, 3072
    s_nop 0
    buffer_load_dwordx4 v13, s[20:23], s52 offen lds
    s_add_u32 m0, s56, 0
    s_nop 0
    buffer_load_dwordx4 v15, s[24:27], s53 offen lds
    s_add_u32 m0, s56, 8192
    s_nop 0
    buffer_load_dwordx4 v15, s[24:27], s54 offen lds
    s_waitcnt lgkmcnt(7)
    v_mfma_f32_16x16x32_bf16 v[32:35], v[104:107], v[176:179], v[32:35]
    ds_read_b64_tr_b16 v[184:185], v25 offset:4096
    v_mfma_f32_16x16x32_bf16 v[36:39], v[104:107], v[180:183], v[36:39]
    ds_read_b64_tr_b16 v[186:187], v25 offset:4608
    s_waitcnt lgkmcnt(8)
    v_mfma_f32_16x16x32_bf16 v[40:43], v[108:111], v[176:179], v[40:43]
    ds_read_b64_tr_b16 v[188:189], v25 offset:12288
    v_mfma_f32_16x16x32_bf16 v[44:47], v[108:111], v[180:183], v[44:47]
    ds_read_b64_tr_b16 v[190:191], v25 offset:12800
    s_waitcnt lgkmcnt(9)
    v_mfma_f32_16x16x32_bf16 v[48:51], v[112:115], v[176:179], v[48:51]
    ds_read_b128 v[140:143], v21 offset:16384
    v_mfma_f32_16x16x32_bf16 v[52:55], v[112:115], v[180:183], v[52:55]
    ds_read_b128 v[144:147], v21 offset:18432
    s_waitcnt lgkmcnt(10)
    v_mfma_f32_16x16x32_bf16 v[56:59], v[116:119], v[176:179], v[56:59]
    ds_read_b128 v[148:151], v21 offset:20480
    v_mfma_f32_16x16x32_bf16 v[60:63], v[116:119], v[180:183], v[60:63]
    ds_read_b128 v[152:155], v21 offset:22528
    s_waitcnt lgkmcnt(11)
    v_mfma_f32_16x16x32_bf16 v[64:67], v[120:123], v[176:179], v[64:67]
    ds_read_b128 v[156:159], v21 offset:24576
    v_mfma_f32_16x16x32_bf16 v[68:71], v[120:123], v[180:183], v[68:71]
    ds_read_b128 v[160:163], v21 offset:26624
    s_waitcnt lgkmcnt(12)
    v_mfma_f32_16x16x32_bf16 v[72:75], v[124:127], v[176:179], v[72:75]
    ds_read_b128 v[164:167], v21 offset:28672
    v_mfma_f32_16x16x32_bf16 v[76:79], v[124:127], v[180:183], v[76:79]
    ds_read_b128 v[168:171], v21 offset:30720
    s_waitcnt lgkmcnt(13)
    v_mfma_f32_16x16x32_bf16 v[80:83], v[128:131], v[176:179], v[80:83]
    v_perm_b32 v212, v230, v226, s61
    v_mfma_f32_16x16x32_bf16 v[84:87], v[128:131], v[180:183], v[84:87]
    v_perm_b32 v213, v238, v234, s61
    s_waitcnt lgkmcnt(12)
    v_mfma_f32_16x16x32_bf16 v[88:91], v[132:135], v[176:179], v[88:91]
    v_perm_b32 v214, v246, v242, s61
    v_mfma_f32_16x16x32_bf16 v[92:95], v[132:135], v[180:183], v[92:95]
    v_perm_b32 v215, v254, v250, s61
    s_waitcnt vmcnt(6) lgkmcnt(0)
    s_barrier
    s_xor_b32 s52, s92, 7
    s_add_u32 s52, s47, s52
    s_and_b32 s52, s52, 7
    s_lshl_b32 s53, s52, 17
    s_lshl_b32 s52, s52, 7
    s_add_u32 s54, s53, 1024
    s_cmp_eq_u32 s44, 7
    s_cbranch_scc0 L_noS_7
    s_mov_b32 m0, 99328
    s_nop 0
    buffer_load_dwordx4 v14, s[20:23], s52 offen lds
L_noS_7:
    s_add_u32 m0, s57, 50176
    s_nop 0
    buffer_load_dwordx4 v10, s[20:23], s52 offen lds
    s_add_u32 m0, s57, 51200
    s_nop 0
    buffer_load_dwordx4 v11, s[20:23], s52 offen lds
    s_add_u32 m0, s57, 52224
    s_nop 0
    buffer_load_dwordx4 v12, s[20:23], s52 offen lds
    s_add_u32 m0, s57, 53248
    s_nop 0
    buffer_load_dwordx4 v13, s[20:23], s52 offen lds
    s_add_u32 m0, s56, 50176
    s_nop 0
    buffer_load_dwordx4 v15, s[24:27], s53 offen lds
    s_add_u32 m0, s56, 58368
    s_nop 0
    buffer_load_dwordx4 v15, s[24:27], s54 offen lds
    v_mfma_f32_16x16x32_bf16 v[32:35], v[140:143], v[184:187], v[32:35]
    ds_read_b64_tr_b16 v[176:177], v26 offset:0
    v_mfma_f32_16x16x32_bf16 v[36:39], v[140:143], v[188:191], v[36:39]
    ds_read_b64_tr_b16 v[178:179], v26 offset:512
    v_mfma_f32_16x16x32_bf16 v[40:43], v[144:147], v[184:187], v[40:43]
    ds_read_b64_tr_b16 v[180:181], v26 offset:8192
    v_mfma_f32_16x16x32_bf16 v[44:47], v[144:147], v[188:191], v[44:47]
    ds_read_b64_tr_b16 v[182:183], v26 offset:8704
    v_mfma_f32_16x16x32_bf16 v[48:51], v[148:151], v[184:187], v[48:51]
    ds_read_b128 v[104:107], v22 offset:16384
    v_mfma_f32_16x16x32_bf16 v[52:55], v[148:151], v[188:191], v[52:55]
    ds_read_b128 v[108:111], v22 offset:18432
    v_mfma_f32_16x16x32_bf16 v[56:59], v[152:155], v[184:187], v[56:59]
    ds_read_b128 v[112:115], v22 offset:20480
    v_mfma_f32_16x16x32_bf16 v[60:63], v[152:155], v[188:191], v[60:63]
    ds_read_b128 v[116:119], v22 offset:22528
    v_mfma_f32_16x16x32_bf16 v[64:67], v[156:159], v[184:187], v[64:67]
    ds_read_b128 v[120:123], v22 offset:24576
    v_mfma_f32_16x16x32_bf16 v[68:71], v[156:159], v[188:191], v[68:71]
    ds_read_b128 v[124:127], v22 offset:26624
    v_mfma_f32_16x16x32_bf16 v[72:75], v[160:163], v[184:187], v[72:75]
    ds_read_b128 v[128:131], v22 offset:28672
    v_mfma_f32_16x16x32_bf16 v[76:79], v[160:163], v[188:191], v[76:79]
    ds_read_b128 v[132:135], v22 offset:30720
    v_mfma_f32_16x16x32_bf16 v[80:83], v[164:167], v[184:187], v[80:83]
    v_perm_b32 v216, v231, v227, s60
    v_mfma_f32_16x16x32_bf16 v[84:87], v[164:167], v[188:191], v[84:87]
    v_perm_b32 v217, v239, v235, s60
    v_mfma_f32_16x16x32_bf16 v[88:91], v[168:171], v[184:187], v[88:91]
    v_perm_b32 v218, v247, v243, s60
    v_mfma_f32_16x16x32_bf16 v[92:95], v[168:171], v[188:191], v[92:95]
    v_perm_b32 v219, v255, v251, s60
    s_waitcnt lgkmcnt(7)
    v_mfma_f32_16x16x32_bf16 v[32:35], v[104:107], v[176:179], v[32:35]
    ds_read_b64_tr_b16 v[184:185], v26 offset:4096
    v_mfma_f32_16x16x32_bf16 v[36:39], v[104:107], v[180:183], v[36:39]
    ds_read_b64_tr_b16 v[186:187], v26 offset:4608
    s_waitcnt lgkmcnt(8)
    v_mfma_f32_16x16x32_bf16 v[40:43], v[108:111], v[176:179], v[40:43]
    ds_read_b64_tr_b16 v[188:189], v26 offset:12288
    v_mfma_f32_16x16x32_bf16 v[44:47], v[108:111], v[180:183], v[44:47]
    ds_read_b64_tr_b16 v[190:191], v26 offset:12800
    s_waitcnt lgkmcnt(9)
    v_mfma_f32_16x16x32_bf16 v[48:51], v[112:115], v[176:179], v[48:51]
    ds_read_b128 v[140:143], v23 offset:16384
    v_mfma_f32_16x16x32_bf16 v[52:55], v[112:115], v[180:183], v[52:55]
    ds_read_b128 v[144:147], v23 offset:18432
    s_waitcnt lgkmcnt(10)
    v_mfma_f32_16x16x32_bf16 v[56:59], v[116:119], v[176:179], v[56:59]
    ds_read_b128 v[148:151], v23 offset:20480
    v_mfma_f32_16x16x32_bf16 v[60:63], v[116:119], v[180:183], v[60:63]
    ds_read_b128 v[152:155], v23 offset:22528
    s_waitcnt lgkmcnt(11)
    v_mfma_f32_16x16x32_bf16 v[64:67], v[120:123], v[176:179], v[64:67]
    ds_read_b128 v[156:159], v23 offset:24576
    v_mfma_f32_16x16x32_bf16 v[68:71], v[120:123], v[180:183], v[68:71]
    ds_read_b128 v[160:163], v23 offset:26624
    s_waitcnt lgkmcnt(12)
    v_mfma_f32_16x16x32_bf16 v[72:75], v[124:127], v[176:179], v[72:75]
    ds_read_b128 v[164:167], v23 offset:28672
    v_mfma_f32_16x16x32_bf16 v[76:79], v[124:127], v[180:183], v[76:79]
    ds_read_b128 v[168:171], v23 offset:30720
    s_waitcnt lgkmcnt(13)
    v_mfma_f32_16x16x32_bf16 v[80:83], v[128:131], v[176:179], v[80:83]
    v_perm_b32 v220, v231, v227, s61
    v_mfma_f32_16x16x32_bf16 v[84:87], v[128:131], v[180:183], v[84:87]
    v_perm_b32 v221, v239, v235, s61
    s_waitcnt lgkmcnt(12)
    v_mfma_f32_16x16x32_bf16 v[88:91], v[132:135], v[176:179], v[88:91]
    v_perm_b32 v222, v247, v243, s61
    v_mfma_f32_16x16x32_bf16 v[92:95], v[132:135], v[180:183], v[92:95]
    v_perm_b32 v223, v255, v251, s61
    s_waitcnt vmcnt(6) lgkmcnt(0)
    s_barrier
    s_setprio 3
    global_load_dwordx2 v[30:31], v28, s[14:15] sc1
    v_mfma_f32_16x16x32_bf16 v[32:35], v[140:143], v[184:187], v[32:35]
    ds_read_b64_tr_b16 v[176:177], v24 offset:0
    v_mfma_f32_16x16x32_bf16 v[36:39], v[140:143], v[188:191], v[36:39]
    ds_read_b64_tr_b16 v[178:179], v24 offset:512
    v_mfma_f32_16x16x32_bf16 v[40:43], v[144:147], v[184:187], v[40:43]
    ds_read_b64_tr_b16 v[180:181], v24 offset:8192
    v_mfma_f32_16x16x32_bf16 v[44:47], v[144:147], v[188:191], v[44:47]
    ds_read_b64_tr_b16 v[182:183], v24 offset:8704
    v_mfma_f32_16x16x32_bf16 v[48:51], v[148:151], v[184:187], v[48:51]
    ds_read_b128 v[104:107], v18 offset:16384
    v_mfma_f32_16x16x32_bf16 v[52:55], v[148:151], v[188:191], v[52:55]
    ds_read_b128 v[108:111], v18 offset:18432
    v_mfma_f32_16x16x32_bf16 v[56:59], v[152:155], v[184:187], v[56:59]
    ds_read_b128 v[112:115], v18 offset:20480
    v_mfma_f32_16x16x32_bf16 v[60:63], v[152:155], v[188:191], v[60:63]
    ds_read_b128 v[116:119], v18 offset:22528
    v_mfma_f32_16x16x32_bf16 v[64:67], v[156:159], v[184:187], v[64:67]
    ds_read_b128 v[120:123], v18 offset:24576
    v_mfma_f32_16x16x32_bf16 v[68:71], v[156:159], v[188:191], v[68:71]
    ds_read_b128 v[124:127], v18 offset:26624
    v_mfma_f32_16x16x32_bf16 v[72:75], v[160:163], v[184:187], v[72:75]
    ds_read_b128 v[128:131], v18 offset:28672
    v_mfma_f32_16x16x32_bf16 v[76:79], v[160:163], v[188:191], v[76:79]
    ds_read_b128 v[132:135], v18 offset:30720
    v_mfma_f32_16x16x32_bf16 v[80:83], v[164:167], v[184:187], v[80:83]
    v_mfma_f32_16x16x32_bf16 v[84:87], v[164:167], v[188:191], v[84:87]
    v_mfma_f32_16x16x32_bf16 v[88:91], v[168:171], v[184:187], v[88:91]
    v_mfma_f32_16x16x32_bf16 v[92:95], v[168:171], v[188:191], v[92:95]
    s_waitcnt lgkmcnt(7)
    v_mfma_f32_16x16x32_bf16 v[32:35], v[104:107], v[176:179], v[32:35]
    ds_read_b64_tr_b16 v[184:185], v24 offset:4096
    v_mfma_f32_16x16x32_bf16 v[36:39], v[104:107], v[180:183], v[36:39]
    ds_read_b64_tr_b16 v[186:187], v24 offset:4608
    s_waitcnt lgkmcnt(8)
    v_mfma_f32_16x16x32_bf16 v[40:43], v[108:111], v[176:179], v[40:43]
    ds_read_b64_tr_b16 v[188:189], v24 offset:12288
    v_mfma_f32_16x16x32_bf16 v[44:47], v[108:111], v[180:183], v[44:47]
    ds_read_b64_tr_b16 v[190:191], v24 offset:12800
    s_waitcnt lgkmcnt(9)
    v_mfma_f32_16x16x32_bf16 v[48:51], v[112:115], v[176:179], v[48:51]
    ds_read_b128 v[140:143], v19 offset:16384
    v_mfma_f32_16x16x32_bf16 v[52:55], v[112:115], v[180:183], v[52:55]
    ds_read_b128 v[144:147], v19 offset:18432
    s_waitcnt lgkmcnt(10)
    v_mfma_f32_16x16x32_bf16 v[56:59], v[116:119], v[176:179], v[56:59]
    ds_read_b128 v[148:151], v19 offset:20480
    v_mfma_f32_16x16x32_bf16 v[60:63], v[116:119], v[180:183], v[60:63]
    ds_read_b128 v[152:155], v19 offset:22528
    s_waitcnt lgkmcnt(11)
    v_mfma_f32_16x16x32_bf16 v[64:67], v[120:123], v[176:179], v[64:67]
    ds_read_b128 v[156:159], v19 offset:24576
    v_mfma_f32_16x16x32_bf16 v[68:71], v[120:123], v[180:183], v[68:71]
    ds_read_b128 v[160:163], v19 offset:26624
    s_waitcnt lgkmcnt(12)
    v_mfma_f32_16x16x32_bf16 v[72:75], v[124:127], v[176:179], v[72:75]
    ds_read_b128 v[164:167], v19 offset:28672
    v_mfma_f32_16x16x32_bf16 v[76:79], v[124:127], v[180:183], v[76:79]
    ds_read_b128 v[168:171], v19 offset:30720
    s_waitcnt lgkmcnt(13)
    v_mfma_f32_16x16x32_bf16 v[80:83], v[128:131], v[176:179], v[80:83]
    v_mfma_f32_16x16x32_bf16 v[84:87], v[128:131], v[180:183], v[84:87]
    s_waitcnt lgkmcnt(12)
    v_mfma_f32_16x16x32_bf16 v[88:91], v[132:135], v[176:179], v[88:91]
    v_mfma_f32_16x16x32_bf16 v[92:95], v[132:135], v[180:183], v[92:95]
    s_waitcnt vmcnt(1) lgkmcnt(0)
    s_barrier
    v_mfma_f32_16x16x32_bf16 v[32:35], v[140:143], v[184:187], v[32:35]
    ds_read_b64_tr_b16 v[176:177], v25 offset:0
    v_mfma_f32_16x16x32_bf16 v[36:39], v[140:143], v[188:191], v[36:39]
    ds_read_b64_tr_b16 v[178:179], v25 offset:512
    v_mfma_f32_16x16x32_bf16 v[40:43], v[144:147], v[184:187], v[40:43]
    ds_read_b64_tr_b16 v[180:181], v25 offset:8192
    v_mfma_f32_16x16x32_bf16 v[44:47], v[144:147], v[188:191], v[44:47]
    ds_read_b64_tr_b16 v[182:183], v25 offset:8704
    v_mfma_f32_16x16x32_bf16 v[48:51], v[148:151], v[184:187], v[48:51]
    ds_read_b128 v[104:107], v20 offset:16384
    v_mfma_f32_16x16x32_bf16 v[52:55], v[148:151], v[188:191], v[52:55]
    ds_read_b128 v[108:111], v20 offset:18432
    v_mfma_f32_16x16x32_bf16 v[56:59], v[152:155], v[184:187], v[56:59]
    ds_read_b128 v[112:115], v20 offset:20480
    v_mfma_f32_16x16x32_bf16 v[60:63], v[152:155], v[188:191], v[60:63]
    ds_read_b128 v[116:119], v20 offset:22528
    v_mfma_f32_16x16x32_bf16 v[64:67], v[156:159], v[184:187], v[64:67]
    ds_read_b128 v[120:123], v20 offset:24576
    v_mfma_f32_16x16x32_bf16 v[68:71], v[156:159], v[188:191], v[68:71]
    ds_read_b128 v[124:127], v20 offset:26624
    v_mfma_f32_16x16x32_bf16 v[72:75], v[160:163], v[184:187], v[72:75]
    ds_read_b128 v[128:131], v20 offset:28672
    v_mfma_f32_16x16x32_bf16 v[76:79], v[160:163], v[188:191], v[76:79]
    ds_read_b128 v[132:135], v20 offset:30720
    v_mfma_f32_16x16x32_bf16 v[80:83], v[164:167], v[184:187], v[80:83]
    v_mfma_f32_16x16x32_bf16 v[84:87], v[164:167], v[188:191], v[84:87]
    v_mfma_f32_16x16x32_bf16 v[88:91], v[168:171], v[184:187], v[88:91]
    v_mfma_f32_16x16x32_bf16 v[92:95], v[168:171], v[188:191], v[92:95]
    s_waitcnt lgkmcnt(7)
    v_mfma_f32_16x16x32_bf16 v[32:35], v[104:107], v[176:179], v[32:35]
    ds_read_b64_tr_b16 v[184:185], v25 offset:4096
    v_mfma_f32_16x16x32_bf16 v[36:39], v[104:107], v[180:183], v[36:39]
    ds_read_b64_tr_b16 v[186:187], v25 offset:4608
    s_waitcnt lgkmcnt(8)
    v_mfma_f32_16x16x32_bf16 v[40:43], v[108:111], v[176:179], v[40:43]
    ds_read_b64_tr_b16 v[188:189], v25 offset:12288
    v_mfma_f32_16x16x32_bf16 v[44:47], v[108:111], v[180:183], v[44:47]
    ds_read_b64_tr_b16 v[190:191], v25 offset:12800
    s_waitcnt lgkmcnt(9)
    v_mfma_f32_16x16x32_bf16 v[48:51], v[112:115], v[176:179], v[48:51]
    ds_read_b128 v[140:143], v21 offset:16384
    v_mfma_f32_16x16x32_bf16 v[52:55], v[112:115], v[180:183], v[52:55]
    ds_read_b128 v[144:147], v21 offset:18432
    s_waitcnt lgkmcnt(10)
    v_mfma_f32_16x16x32_bf16 v[56:59], v[116:119], v[176:179], v[56:59]
    ds_read_b128 v[148:151], v21 offset:20480
    v_mfma_f32_16x16x32_bf16 v[60:63], v[116:119], v[180:183], v[60:63]
    ds_read_b128 v[152:155], v21 offset:22528
    s_waitcnt lgkmcnt(11)
    v_mfma_f32_16x16x32_bf16 v[64:67], v[120:123], v[176:179], v[64:67]
    ds_read_b128 v[156:159], v21 offset:24576
    v_mfma_f32_16x16x32_bf16 v[68:71], v[120:123], v[180:183], v[68:71]
    ds_read_b128 v[160:163], v21 offset:26624
    s_waitcnt lgkmcnt(12)
    v_mfma_f32_16x16x32_bf16 v[72:75], v[124:127], v[176:179], v[72:75]
    ds_read_b128 v[164:167], v21 offset:28672
    v_mfma_f32_16x16x32_bf16 v[76:79], v[124:127], v[180:183], v[76:79]
    ds_read_b128 v[168:171], v21 offset:30720
    s_waitcnt lgkmcnt(13)
    v_mfma_f32_16x16x32_bf16 v[80:83], v[128:131], v[176:179], v[80:83]
    v_mfma_f32_16x16x32_bf16 v[84:87], v[128:131], v[180:183], v[84:87]
    s_waitcnt lgkmcnt(12)
    v_mfma_f32_16x16x32_bf16 v[88:91], v[132:135], v[176:179], v[88:91]
    v_mfma_f32_16x16x32_bf16 v[92:95], v[132:135], v[180:183], v[92:95]
    s_waitcnt lgkmcnt(7)
    v_mfma_f32_16x16x32_bf16 v[32:35], v[140:143], v[184:187], v[32:35]
    v_mfma_f32_16x16x32_bf16 v[36:39], v[140:143], v[188:191], v[36:39]
    s_waitcnt lgkmcnt(6)
    v_mfma_f32_16x16x32_bf16 v[40:43], v[144:147], v[184:187], v[40:43]
    v_mfma_f32_16x16x32_bf16 v[44:47], v[144:147], v[188:191], v[44:47]
    s_waitcnt lgkmcnt(5)
    v_mfma_f32_16x16x32_bf16 v[48:51], v[148:151], v[184:187], v[48:51]
    v_mfma_f32_16x16x32_bf16 v[52:55], v[148:151], v[188:191], v[52:55]
    s_waitcnt lgkmcnt(4)
    v_mfma_f32_16x16x32_bf16 v[56:59], v[152:155], v[184:187], v[56:59]
    v_mfma_f32_16x16x32_bf16 v[60:63], v[152:155], v[188:191], v[60:63]
    s_waitcnt lgkmcnt(3)
    v_mfma_f32_16x16x32_bf16 v[64:67], v[156:159], v[184:187], v[64:67]
    v_mfma_f32_16x16x32_bf16 v[68:71], v[156:159], v[188:191], v[68:71]
    s_waitcnt lgkmcnt(2)
    v_mfma_f32_16x16x32_bf16 v[72:75], v[160:163], v[184:187], v[72:75]
    v_mfma_f32_16x16x32_bf16 v[76:79], v[160:163], v[188:191], v[76:79]
    s_waitcnt lgkmcnt(1)
    v_mfma_f32_16x16x32_bf16 v[80:83], v[164:167], v[184:187], v[80:83]
    v_mfma_f32_16x16x32_bf16 v[84:87], v[164:167], v[188:191], v[84:87]
    s_waitcnt lgkmcnt(0)
    v_mfma_f32_16x16x32_bf16 v[88:91], v[168:171], v[184:187], v[88:91]
    v_mfma_f32_16x16x32_bf16 v[92:95], v[168:171], v[188:191], v[92:95]
    s_setprio 0
    s_lshl_b32 s52, s48, 4
    v_add_u32 v5, s52, v3
    v_mul_u32_u24 v5, 560, v5
    v_add_u32 v5, 100352, v5
    v_lshl_add_u32 v6, v4, 4, v5
    v_lshl_add_u32 v7, v4, 3, v5
    s_nop 1
    v_mul_f32 v104, s64, v36
    v_mul_f32 v105, s64, v37
    v_mul_f32 v106, s64, v38
    v_mul_f32 v107, s64, v39
    v_mul_f32 v108, s64, v44
    v_mul_f32 v109, s64, v45
    v_mul_f32 v110, s64, v46
    v_mul_f32 v111, s64, v47
    v_exp_f32 v104, v104
    v_exp_f32 v105, v105
    v_exp_f32 v106, v106
    v_exp_f32 v107, v107
    v_exp_f32 v108, v108
    v_exp_f32 v109, v109
    v_exp_f32 v110, v110
    v_exp_f32 v111, v111
    v_add_f32 v104, 1.0, v104
    v_add_f32 v105, 1.0, v105
    v_add_f32 v106, 1.0, v106
    v_add_f32 v107, 1.0, v107
    v_add_f32 v108, 1.0, v108
    v_add_f32 v109, 1.0, v109
    v_add_f32 v110, 1.0, v110
    v_add_f32 v111, 1.0, v111
    v_rcp_f32 v104, v104
    v_rcp_f32 v105, v105
    v_rcp_f32 v106, v106
    v_rcp_f32 v107, v107
    v_rcp_f32 v108, v108
    v_rcp_f32 v109, v109
    v_rcp_f32 v110, v110
    v_rcp_f32 v111, v111
    v_mul_f32 v104, v32, v104
    v_mul_f32 v105, v33, v105
    v_mul_f32 v106, v34, v106
    v_mul_f32 v107, v35, v107
    v_mul_f32 v108, v40, v108
    v_mul_f32 v109, v41, v109
    v_mul_f32 v110, v42, v110
    v_mul_f32 v111, v43, v111
    v_cvt_pk_bf16_f32 v112, v104, v105
    v_cvt_pk_bf16_f32 v113, v106, v107
    v_cvt_pk_bf16_f32 v114, v108, v109
    v_cvt_pk_bf16_f32 v115, v110, v111
    ds_write_b128 v6, v[112:115] offset:256
    v_mul_f32 v104, s64, v52
    v_mul_f32 v105, s64, v53
    v_mul_f32 v106, s64, v54
    v_mul_f32 v107, s64, v55
    v_mul_f32 v108, s64, v60
    v_mul_f32 v109, s64, v61
    v_mul_f32 v110, s64, v62
    v_mul_f32 v111, s64, v63
    v_exp_f32 v104, v104
    v_exp_f32 v105, v105
    v_exp_f32 v106, v106
    v_exp_f32 v107, v107
    v_exp_f32 v108, v108
    v_exp_f32 v109, v109
    v_exp_f32 v110, v110
    v_exp_f32 v111, v111
    v_add_f32 v104, 1.0, v104
    v_add_f32 v105, 1.0, v105
    v_add_f32 v106, 1.0, v106
    v_add_f32 v107, 1.0, v107
    v_add_f32 v108, 1.0, v108
    v_add_f32 v109, 1.0, v109
    v_add_f32 v110, 1.0, v110
    v_add_f32 v111, 1.0, v111
    v_rcp_f32 v104, v104
    v_rcp_f32 v105, v105
    v_rcp_f32 v106, v106
    v_rcp_f32 v107, v107
    v_rcp_f32 v108, v108
    v_rcp_f32 v109, v109
    v_rcp_f32 v110, v110
    v_rcp_f32 v111, v111
    v_mul_f32 v104, v48, v104
    v_mul_f32 v105, v49, v105
    v_mul_f32 v106, v50, v106
    v_mul_f32 v107, v51, v107
    v_mul_f32 v108, v56, v108
    v_mul_f32 v109, v57, v109
    v_mul_f32 v110, v58, v110
    v_mul_f32 v111, v59, v111
    v_cvt_pk_bf16_f32 v116, v104, v105
    v_cvt_pk_bf16_f32 v117, v106, v107
    v_cvt_pk_bf16_f32 v118, v108, v109
    v_cvt_pk_bf16_f32 v119, v110, v111
    ds_write_b128 v6, v[116:119] offset:320
    v_mul_f32 v104, s64, v68
    v_mul_f32 v105, s64, v69
    v_mul_f32 v106, s64, v70
    v_mul_f32 v107, s64, v71
    v_mul_f32 v108, s64, v76
    v_mul_f32 v109, s64, v77
    v_mul_f32 v110, s64, v78
    v_mul_f32 v111, s64, v79
    v_exp_f32 v104, v104
    v_exp_f32 v105, v105
    v_exp_f32 v106, v106
    v_exp_f32 v107, v107
    v_exp_f32 v108, v108
    v_exp_f32 v109, v109
    v_exp_f32 v110, v110
    v_exp_f32 v111, v111
    v_add_f32 v104, 1.0, v104
    v_add_f32 v105, 1.0, v105
    v_add_f32 v106, 1.0, v106
    v_add_f32 v107, 1.0, v107
    v_add_f32 v108, 1.0, v108
    v_add_f32 v109, 1.0, v109
    v_add_f32 v110, 1.0, v110
    v_add_f32 v111, 1.0, v111
    v_rcp_f32 v104, v104
    v_rcp_f32 v105, v105
    v_rcp_f32 v106, v106
    v_rcp_f32 v107, v107
    v_rcp_f32 v108, v108
    v_rcp_f32 v109, v109
    v_rcp_f32 v110, v110
    v_rcp_f32 v111, v111
    v_mul_f32 v104, v64, v104
    v_mul_f32 v105, v65, v105
    v_mul_f32 v106, v66, v106
    v_mul_f32 v107, v67, v107
    v_mul_f32 v108, v72, v108
    v_mul_f32 v109, v73, v109
    v_mul_f32 v110, v74, v110
    v_mul_f32 v111, v75, v111
    v_cvt_pk_bf16_f32 v112, v104, v105
    v_cvt_pk_bf16_f32 v113, v106, v107
    v_cvt_pk_bf16_f32 v114, v108, v109
    v_cvt_pk_bf16_f32 v115, v110, v111
    ds_write_b128 v6, v[112:115] offset:384
    v_mul_f32 v104, s64, v84
    v_mul_f32 v105, s64, v85
    v_mul_f32 v106, s64, v86
    v_mul_f32 v107, s64, v87
    v_mul_f32 v108, s64, v92
    v_mul_f32 v109, s64, v93
    v_mul_f32 v110, s64, v94
    v_mul_f32 v111, s64, v95
    v_exp_f32 v104, v104
    v_exp_f32 v105, v105
    v_exp_f32 v106, v106
    v_exp_f32 v107, v107
    v_exp_f32 v108, v108
    v_exp_f32 v109, v109
    v_exp_f32 v110, v110
    v_exp_f32 v111, v111
    v_add_f32 v104, 1.0, v104
    v_add_f32 v105, 1.0, v105
    v_add_f32 v106, 1.0, v106
    v_add_f32 v107, 1.0, v107
    v_add_f32 v108, 1.0, v108
    v_add_f32 v109, 1.0, v109
    v_add_f32 v110, 1.0, v110
    v_add_f32 v111, 1.0, v111
    v_rcp_f32 v104, v104
    v_rcp_f32 v105, v105
    v_rcp_f32 v106, v106
    v_rcp_f32 v107, v107
    v_rcp_f32 v108, v108
    v_rcp_f32 v109, v109
    v_rcp_f32 v110, v110
    v_rcp_f32 v111, v111
    v_mul_f32 v104, v80, v104
    v_mul_f32 v105, v81, v105
    v_mul_f32 v106, v82, v106
    v_mul_f32 v107, v83, v107
    v_mul_f32 v108, v88, v108
    v_mul_f32 v109, v89, v109
    v_mul_f32 v110, v90, v110
    v_mul_f32 v111, v91, v111
    v_cvt_pk_bf16_f32 v116, v104, v105
    v_cvt_pk_bf16_f32 v117, v106, v107
    v_cvt_pk_bf16_f32 v118, v108, v109
    v_cvt_pk_bf16_f32 v119, v110, v111
    ds_write_b128 v6, v[116:119] offset:448
    s_mul_i32 s52, s44, 4480
    s_add_u32 s52, s52, 100352
    v_lshlrev_b32 v5, 5, v3
    v_lshl_add_u32 v5, v4, 4, v5
    v_add_u32 v5, s52, v5
    s_lshl_b32 s54, s46, 3
    s_add_u32 s54, s54, s44
    s_lshl_b32 s53, s54, 3
    v_mov_b32 v11, s53
    s_lshl_b32 s54, s54, 9
    s_lshl_b32 s55, s45, 18
    s_add_u32 s54, s54, s55
    v_lshlrev_b32 v6, 16, v4
    v_lshl_add_u32 v6, v3, 4, v6
    v_add_u32 v7, 0x8000, v6
    s_lshl_b32 s55, s45, 9
    s_add_u32 s55, s55, 8388608
    s_lshl_b32 s57, s48, 10
    v_mov_b32 v14, 155136
    v_mov_b32 v15, 1
    s_waitcnt vmcnt(0)
    s_waitcnt lgkmcnt(0)
    s_barrier
    ds_read_b128 v[32:35], v5 offset:0
    ds_read_b128 v[36:39], v5 offset:560
    ds_read_b128 v[40:43], v5 offset:1120
    ds_read_b128 v[44:47], v5 offset:1680
    ds_read_b128 v[48:51], v5 offset:2240
    ds_read_b128 v[52:55], v5 offset:2800
    ds_read_b128 v[56:59], v5 offset:3360
    ds_read_b128 v[60:63], v5 offset:3920
    s_add_u32 s90, s46, 2
    s_and_b32 s90, s90, 7
    s_lshl_b32 s90, s90, 16
    s_add_u32 s91, s90, 128
    s_add_u32 m0, s57, 0
    s_nop 0
    buffer_load_dwordx4 v27, s[40:43], s90 offen lds
    s_add_u32 m0, s57, 4096
    s_nop 0
    buffer_load_dwordx4 v27, s[40:43], s91 offen lds
    s_add_u32 s90, s46, 3
    s_and_b32 s90, s90, 7
    s_lshl_b32 s90, s90, 16
    s_add_u32 s91, s90, 128
    s_add_u32 m0, s57, 8192
    s_nop 0
    buffer_load_dwordx4 v27, s[40:43], s90 offen lds
    s_add_u32 m0, s57, 12288
    s_nop 0
    buffer_load_dwordx4 v27, s[40:43], s91 offen lds
    s_add_u32 s90, s46, 4
    s_and_b32 s90, s90, 7
    s_lshl_b32 s90, s90, 16
    s_add_u32 s91, s90, 128
    s_add_u32 m0, s57, 16384
    s_nop 0
    buffer_load_dwordx4 v27, s[40:43], s90 offen lds
    s_add_u32 m0, s57, 20480
    s_nop 0
    buffer_load_dwordx4 v27, s[40:43], s91 offen lds
    s_add_u32 s90, s46, 5
    s_and_b32 s90, s90, 7
    s_lshl_b32 s90, s90, 16
    s_add_u32 s91, s90, 128
    s_add_u32 m0, s57, 24576
    s_nop 0
    buffer_load_dwordx4 v27, s[40:43], s90 offen lds
    s_add_u32 m0, s57, 28672
    s_nop 0
    buffer_load_dwordx4 v27, s[40:43], s91 offen lds
    s_add_u32 s90, s46, 6
    s_and_b32 s90, s90, 7
    s_lshl_b32 s90, s90, 16
    s_add_u32 s91, s90, 128
    s_add_u32 m0, s57, 32768
    s_nop 0
    buffer_load_dwordx4 v27, s[40:43], s90 offen lds
    s_add_u32 m0, s57, 36864
    s_nop 0
    buffer_load_dwordx4 v27, s[40:43], s91 offen lds
    s_add_u32 s90, s46, 7
    s_and_b32 s90, s90, 7
    s_lshl_b32 s90, s90, 16
    s_add_u32 s91, s90, 128
    s_add_u32 m0, s57, 40960
    s_nop 0
    buffer_load_dwordx4 v27, s[40:43], s90 offen lds
    s_add_u32 m0, s57, 45056
    s_nop 0
    buffer_load_dwordx4 v27, s[40:43], s91 offen lds
    s_add_u32 s90, s46, 0
    s_and_b32 s90, s90, 7
    s_lshl_b32 s90, s90, 16
    s_add_u32 s91, s90, 128
    s_add_u32 m0, s57, 50176
    s_nop 0
    buffer_load_dwordx4 v29, s[40:43], s90 offen lds
    s_add_u32 m0, s57, 54272
    s_nop 0
    buffer_load_dwordx4 v29, s[40:43], s91 offen lds
    s_add_u32 s90, s46, 1
    s_and_b32 s90, s90, 7
    s_lshl_b32 s90, s90, 16
    s_add_u32 s91, s90, 128
    s_add_u32 m0, s57, 58368
    s_nop 0
    buffer_load_dwordx4 v29, s[40:43], s90 offen lds
    s_add_u32 m0, s57, 62464
    s_nop 0
    buffer_load_dwordx4 v29, s[40:43], s91 offen lds
    s_add_u32 s90, s46, 2
    s_and_b32 s90, s90, 7
    s_lshl_b32 s90, s90, 16
    s_add_u32 s91, s90, 128
    s_add_u32 m0, s57, 66560
    s_nop 0
    buffer_load_dwordx4 v29, s[40:43], s90 offen lds
    s_add_u32 m0, s57, 70656
    s_nop 0
    buffer_load_dwordx4 v29, s[40:43], s91 offen lds
    s_waitcnt lgkmcnt(7)
    v_mfma_f32_16x16x32_bf16 v[64:67], v[32:35], v[192:195], 0
    s_waitcnt lgkmcnt(6)
    v_mfma_f32_16x16x32_bf16 v[68:71], v[36:39], v[196:199], 0
    s_waitcnt lgkmcnt(5)
    v_mfma_f32_16x16x32_bf16 v[72:75], v[40:43], v[200:203], 0
    s_waitcnt lgkmcnt(4)
    v_mfma_f32_16x16x32_bf16 v[76:79], v[44:47], v[204:207], 0
    s_waitcnt lgkmcnt(3)
    v_mfma_f32_16x16x32_bf16 v[80:83], v[48:51], v[208:211], 0
    s_waitcnt lgkmcnt(2)
    v_mfma_f32_16x16x32_bf16 v[84:87], v[52:55], v[212:215], 0
    s_waitcnt lgkmcnt(1)
    v_mfma_f32_16x16x32_bf16 v[88:91], v[56:59], v[216:219], 0
    s_waitcnt lgkmcnt(0)
    v_mfma_f32_16x16x32_bf16 v[92:95], v[60:63], v[220:223], 0
    v_readfirstlane_b32 s58, v30
    v_readfirstlane_b32 s63, v31
    s_lshl_b32 s52, 8, s49
    s_cmp_eq_u32 s63, s52
    s_cselect_b32 s63, 1, 0
    s_nop 2
    v_pk_mul_f32 v[96:97], v[64:65], s[64:65]
    v_pk_mul_f32 v[98:99], v[68:69], s[64:65]
    v_pk_mul_f32 v[100:101], v[72:73], s[64:65]
    v_pk_mul_f32 v[102:103], v[76:77], s[64:65]
    v_pk_mul_f32 v[104:105], v[80:81], s[64:65]
    v_pk_mul_f32 v[106:107], v[84:85], s[64:65]
    v_pk_mul_f32 v[108:109], v[88:89], s[64:65]
    v_pk_mul_f32 v[110:111], v[92:93], s[64:65]
    v_exp_f32 v96, v96
    v_exp_f32 v97, v97
    v_exp_f32 v98, v98
    v_exp_f32 v99, v99
    v_exp_f32 v100, v100
    v_exp_f32 v101, v101
    v_exp_f32 v102, v102
    v_exp_f32 v103, v103
    v_exp_f32 v104, v104
    v_exp_f32 v105, v105
    v_exp_f32 v106, v106
    v_exp_f32 v107, v107
    v_exp_f32 v108, v108
    v_exp_f32 v109, v109
    v_exp_f32 v110, v110
    v_exp_f32 v111, v111
    v_pk_add_f32 v[96:97], v[96:97], 1.0 op_sel_hi:[1,0]
    v_pk_add_f32 v[98:99], v[98:99], 1.0 op_sel_hi:[1,0]
    v_pk_add_f32 v[100:101], v[100:101], 1.0 op_sel_hi:[1,0]
    v_pk_add_f32 v[102:103], v[102:103], 1.0 op_sel_hi:[1,0]
    v_pk_add_f32 v[104:105], v[104:105], 1.0 op_sel_hi:[1,0]
    v_pk_add_f32 v[106:107], v[106:107], 1.0 op_sel_hi:[1,0]
    v_pk_add_f32 v[108:109], v[108:109], 1.0 op_sel_hi:[1,0]
    v_pk_add_f32 v[110:111], v[110:111], 1.0 op_sel_hi:[1,0]
    v_rcp_f32 v96, v96
    v_rcp_f32 v97, v97
    v_rcp_f32 v98, v98
    v_rcp_f32 v99, v99
    v_rcp_f32 v100, v100
    v_rcp_f32 v101, v101
    v_rcp_f32 v102, v102
    v_rcp_f32 v103, v103
    v_rcp_f32 v104, v104
    v_rcp_f32 v105, v105
    v_rcp_f32 v106, v106
    v_rcp_f32 v107, v107
    v_rcp_f32 v108, v108
    v_rcp_f32 v109, v109
    v_rcp_f32 v110, v110
    v_rcp_f32 v111, v111
    v_pk_mul_f32 v[96:97], v[64:65], v[96:97]
    v_pk_mul_f32 v[98:99], v[68:69], v[98:99]
    v_pk_mul_f32 v[100:101], v[72:73], v[100:101]
    v_pk_mul_f32 v[102:103], v[76:77], v[102:103]
    v_pk_mul_f32 v[104:105], v[80:81], v[104:105]
    v_pk_mul_f32 v[106:107], v[84:85], v[106:107]
    v_pk_mul_f32 v[108:109], v[88:89], v[108:109]
    v_pk_mul_f32 v[110:111], v[92:93], v[110:111]
    v_cvt_pk_bf16_f32 v160, v96, v98
    v_cvt_pk_bf16_f32 v161, v100, v102
    v_cvt_pk_bf16_f32 v162, v104, v106
    v_cvt_pk_bf16_f32 v163, v108, v110
    v_cvt_pk_bf16_f32 v164, v97, v99
    v_cvt_pk_bf16_f32 v165, v101, v103
    v_cvt_pk_bf16_f32 v166, v105, v107
    v_cvt_pk_bf16_f32 v167, v109, v111
    s_waitcnt vmcnt(0)
    s_mov_b64 exec, 1
    ds_add_u32 v14, v15
    s_mov_b64 exec, -1
    v_pk_mul_f32 v[112:113], v[66:67], s[64:65]
    v_pk_mul_f32 v[114:115], v[70:71], s[64:65]
    v_pk_mul_f32 v[116:117], v[74:75], s[64:65]
    v_pk_mul_f32 v[118:119], v[78:79], s[64:65]
    v_pk_mul_f32 v[120:121], v[82:83], s[64:65]
    v_pk_mul_f32 v[122:123], v[86:87], s[64:65]
    v_pk_mul_f32 v[124:125], v[90:91], s[64:65]
    v_pk_mul_f32 v[126:127], v[94:95], s[64:65]
    v_exp_f32 v112, v112
    v_exp_f32 v113, v113
    v_exp_f32 v114, v114
    v_exp_f32 v115, v115
    v_exp_f32 v116, v116
    v_exp_f32 v117, v117
    v_exp_f32 v118, v118
    v_exp_f32 v119, v119
    v_exp_f32 v120, v120
    v_exp_f32 v121, v121
    v_exp_f32 v122, v122
    v_exp_f32 v123, v123
    v_exp_f32 v124, v124
    v_exp_f32 v125, v125
    v_exp_f32 v126, v126
    v_exp_f32 v127, v127
    v_pk_add_f32 v[112:113], v[112:113], 1.0 op_sel_hi:[1,0]
    v_pk_add_f32 v[114:115], v[114:115], 1.0 op_sel_hi:[1,0]
    v_pk_add_f32 v[116:117], v[116:117], 1.0 op_sel_hi:[1,0]
    v_pk_add_f32 v[118:119], v[118:119], 1.0 op_sel_hi:[1,0]
    v_pk_add_f32 v[120:121], v[120:121], 1.0 op_sel_hi:[1,0]
    v_pk_add_f32 v[122:123], v[122:123], 1.0 op_sel_hi:[1,0]
    v_pk_add_f32 v[124:125], v[124:125], 1.0 op_sel_hi:[1,0]
    v_pk_add_f32 v[126:127], v[126:127], 1.0 op_sel_hi:[1,0]
    v_rcp_f32 v112, v112
    v_rcp_f32 v113, v113
    v_rcp_f32 v114, v114
    v_rcp_f32 v115, v115
    v_rcp_f32 v116, v116
    v_rcp_f32 v117, v117
    v_rcp_f32 v118, v118
    v_rcp_f32 v119, v119
    v_rcp_f32 v120, v120
    v_rcp_f32 v121, v121
    v_rcp_f32 v122, v122
    v_rcp_f32 v123, v123
    v_rcp_f32 v124, v124
    v_rcp_f32 v125, v125
    v_rcp_f32 v126, v126
    v_rcp_f32 v127, v127
    v_pk_mul_f32 v[112:113], v[66:67], v[112:113]
    v_pk_mul_f32 v[114:115], v[70:71], v[114:115]
    v_pk_mul_f32 v[116:117], v[74:75], v[116:117]
    v_pk_mul_f32 v[118:119], v[78:79], v[118:119]
    v_pk_mul_f32 v[120:121], v[82:83], v[120:121]
    v_pk_mul_f32 v[122:123], v[86:87], v[122:123]
    v_pk_mul_f32 v[124:125], v[90:91], v[124:125]
    v_pk_mul_f32 v[126:127], v[94:95], v[126:127]
    v_cvt_pk_bf16_f32 v168, v112, v114
    v_cvt_pk_bf16_f32 v169, v116, v118
    v_cvt_pk_bf16_f32 v170, v120, v122
    v_cvt_pk_bf16_f32 v171, v124, v126
    v_cvt_pk_bf16_f32 v172, v113, v115
    v_cvt_pk_bf16_f32 v173, v117, v119
    v_cvt_pk_bf16_f32 v174, v121, v123
    v_cvt_pk_bf16_f32 v175, v125, v127
    s_cmp_lg_u32 s58, 0
    s_cselect_b32 s63, s63, 0
    s_not_b32 s59, s58
    v_mov_b32 v16, s58
    v_mov_b32 v17, s59
    s_cmp_eq_u32 s63, 1
    s_cbranch_scc0 L_slow1
    buffer_store_dwordx4 v[160:163], v6, s[36:39], s54 offen offset:0 nt
    buffer_store_dwordx4 v[164:167], v6, s[36:39], s54 offen offset:256 nt
    buffer_store_dwordx4 v[168:171], v7, s[36:39], s54 offen offset:0 nt
    buffer_store_dwordx4 v[172:175], v7, s[36:39], s54 offen offset:256 nt
    s_mov_b64 exec, 1
    s_waitcnt vmcnt(0)
    buffer_store_dwordx2 v[16:17], v11, s[36:39], s55 offen
    s_mov_b64 exec, -1
L_join1:
    s_add_u32 s90, s46, 3
    s_and_b32 s90, s90, 7
    s_lshl_b32 s90, s90, 16
    s_add_u32 s91, s90, 128
    s_add_u32 m0, s57, 74752
    s_nop 0
    buffer_load_dwordx4 v29, s[40:43], s90 offen lds
    s_add_u32 m0, s57, 78848
    s_nop 0
    buffer_load_dwordx4 v29, s[40:43], s91 offen lds
    s_add_u32 s90, s46, 4
    s_and_b32 s90, s90, 7
    s_lshl_b32 s90, s90, 16
    s_add_u32 s91, s90, 128
    s_add_u32 m0, s57, 82944
    s_nop 0
    buffer_load_dwordx4 v29, s[40:43], s90 offen lds
    s_add_u32 m0, s57, 87040
    s_nop 0
    buffer_load_dwordx4 v29, s[40:43], s91 offen lds
    s_add_u32 s90, s46, 5
    s_and_b32 s90, s90, 7
    s_lshl_b32 s90, s90, 16
    s_add_u32 s91, s90, 128
    s_add_u32 m0, s57, 91136
    s_nop 0
    buffer_load_dwordx4 v29, s[40:43], s90 offen lds
    s_add_u32 m0, s57, 95232
    s_nop 0
    buffer_load_dwordx4 v29, s[40:43], s91 offen lds
    s_waitcnt vmcnt(0)
    s_barrier
    s_add_u32 s90, s46, 6
    s_and_b32 s90, s90, 7
    s_lshl_b32 s90, s90, 16
    s_add_u32 s91, s90, 128
    s_add_u32 m0, s57, 100352
    s_nop 0
    buffer_load_dwordx4 v29, s[40:43], s90 offen lds
    s_add_u32 m0, s57, 104448
    s_nop 0
    buffer_load_dwordx4 v29, s[40:43], s91 offen lds
    s_add_u32 s90, s46, 7
    s_and_b32 s90, s90, 7
    s_lshl_b32 s90, s90, 16
    s_add_u32 s91, s90, 128
    s_add_u32 m0, s57, 108544
    s_nop 0
    buffer_load_dwordx4 v29, s[40:43], s90 offen lds
    s_add_u32 m0, s57, 112640
    s_nop 0
    buffer_load_dwordx4 v29, s[40:43], s91 offen lds
    s_waitcnt vmcnt(0)
    s_cmp_eq_u32 s44, 4
    s_cbranch_scc0 L_nowb
    s_cmp_eq_u32 s46, 0
    s_cbranch_scc0 L_nowb
    s_cmp_eq_u32 s51, 0
    s_cbranch_scc0 L_nowb
    buffer_wbl2 sc1
L_nowb:
    s_barrier
    s_endpgm
L_slow0:
    buffer_store_dwordx4 v[160:163], v6, s[36:39], s54 offen offset:0 sc1
    buffer_store_dwordx4 v[164:167], v6, s[36:39], s54 offen offset:256 sc1
    buffer_store_dwordx4 v[168:171], v7, s[36:39], s54 offen offset:0 sc1
    buffer_store_dwordx4 v[172:175], v7, s[36:39], s54 offen offset:256 sc1
    s_mov_b32 s62, 0
L_ep_chk0:
    s_cmp_lg_u32 s58, 0
    s_cbranch_scc1 L_ep_ok0
    global_load_dwordx2 v[30:31], v28, s[14:15] sc1
    s_add_u32 s62, s62, 1
    s_waitcnt vmcnt(0)
    v_readfirstlane_b32 s58, v30
    s_cmp_lt_u32 s62, 0x40000
    s_cbranch_scc1 L_ep_chk0
L_ep_ok0:
    s_not_b32 s59, s58
    v_mov_b32 v16, s58
    v_mov_b32 v17, s59
    s_mov_b64 exec, 1
    s_waitcnt vmcnt(0)
    buffer_store_dwordx2 v[16:17], v11, s[36:39], s55 offen sc1
    s_mov_b64 exec, -1
    s_mov_b32 s91, s55
    s_lshr_b32 s52, s46, 2
    s_lshl_b32 s52, s52, 2
    s_add_u32 s52, s52, s44
    s_lshl_b32 s90, s52, 15
    s_lshl_b32 s53, s45, 18
    s_add_u32 s53, s53, s90
    v_lshlrev_b32 v12, 4, v1
    v_add_u32 v12, s53, v12
    v_lshrrev_b32 v5, 2, v3
    v_and_b32 v8, 3, v3
    v_lshrrev_b32 v9, 1, v8
    v_and_b32 v10, 1, v4
    v_lshl_or_b32 v9, v10, 1, v9
    v_lshrrev_b32 v10, 1, v5
    v_lshlrev_b32 v10, 2, v10
    v_lshrrev_b32 v13, 1, v4
    v_lshl_or_b32 v10, v13, 1, v10
    v_xor_b32 v9, v9, v10
    v_lshlrev_b32 v9, 4, v9
    v_lshl_add_u32 v9, v5, 7, v9
    v_lshl_add_u32 v9, v13, 10, v9
    v_and_b32 v8, 1, v8
    v_lshl_add_u32 v22, v8, 3, v9
    v_xor_b32 v23, 64, v22
    v_add_u32 v24, 65536, v22
    v_add_u32 v25, 65536, v23
    v_add_u32 v26, 131072, v22
    v_add_u32 v27, 131072, v23
    s_add_u32 s52, s46, 0
    s_and_b32 s52, s52, 7
    s_lshl_b32 s20, s52, 12
    s_add_u32 s52, s46, 1
    s_and_b32 s52, s52, 7
    s_lshl_b32 s21, s52, 12
    s_add_u32 s52, s46, 2
    s_and_b32 s52, s52, 7
    s_lshl_b32 s22, s52, 12
    s_add_u32 s52, s46, 3
    s_and_b32 s52, s52, 7
    s_lshl_b32 s23, s52, 12
    s_add_u32 s52, s46, 4
    s_and_b32 s52, s52, 7
    s_lshl_b32 s24, s52, 12
    s_add_u32 s52, s46, 5
    s_and_b32 s52, s52, 7
    s_lshl_b32 s25, s52, 12
    s_add_u32 s52, s46, 6
    s_and_b32 s52, s52, 7
    s_lshl_b32 s26, s52, 12
    s_add_u32 s52, s46, 7
    s_and_b32 s52, s52, 7
    s_lshl_b32 s27, s52, 12
    s_lshl_b32 s52, s46, 3
    v_add_u32 v13, s52, v1
    v_and_b32 v13, 63, v13
    v_lshlrev_b32 v13, 3, v13
    s_mov_b32 s62, 0
    s_branch L_join0
L_slow1:
    buffer_store_dwordx4 v[160:163], v6, s[36:39], s54 offen offset:0 sc1
    buffer_store_dwordx4 v[164:167], v6, s[36:39], s54 offen offset:256 sc1
    buffer_store_dwordx4 v[168:171], v7, s[36:39], s54 offen offset:0 sc1
    buffer_store_dwordx4 v[172:175], v7, s[36:39], s54 offen offset:256 sc1
    s_mov_b32 s62, 0
L_ep_chk1:
    s_cmp_lg_u32 s58, 0
    s_cbranch_scc1 L_ep_ok1
    global_load_dwordx2 v[30:31], v28, s[14:15] sc1
    s_add_u32 s62, s62, 1
    s_waitcnt vmcnt(0)
    v_readfirstlane_b32 s58, v30
    s_cmp_lt_u32 s62, 0x40000
    s_cbranch_scc1 L_ep_chk1
L_ep_ok1:
    s_not_b32 s59, s58
    v_mov_b32 v16, s58
    v_mov_b32 v17, s59
    s_mov_b64 exec, 1
    s_waitcnt vmcnt(0)
    buffer_store_dwordx2 v[16:17], v11, s[36:39], s55 offen sc1
    s_mov_b64 exec, -1
    s_branch L_join1
L_code_end:
.section .rodata,"a"
.p2align 6
.amdhsa_kernel standalone__conformer_conv_module__speech_kernel
  .amdhsa_next_free_vgpr 256
  .amdhsa_next_free_sgpr 102
  .amdhsa_accum_offset 256
  .amdhsa_group_segment_fixed_size 0
  .amdhsa_kernarg_size 56
  .amdhsa_user_sgpr_count 2
  .amdhsa_user_sgpr_kernarg_segment_ptr 1
  .amdhsa_system_sgpr_workgroup_id_x 1
.end_amdhsa_kernel
```
